```python
import torch

def _softmax(x, axis=-1):
    return torch.softmax(x, dim=axis)
def _gelu(x):
    return torch.nn.functional.gelu(x, approximate="tanh")
def _silu(x):
    return torch.nn.functional.silu(x)
def _sigmoid(x):
    return torch.sigmoid(x)
def _layernorm(x, axis=-1, eps=1e-5):
    m = x.mean(dim=axis, keepdim=True)
    v = x.var(dim=axis, keepdim=True, unbiased=False)
    return (x - m) / torch.sqrt(v + eps)
def _scatter_add(tgt, idx, src, axis=0):
    return tgt.clone().index_add_(axis, idx, src)
def _segment_sum(src, seg, n):
    out = torch.zeros((n,) + src.shape[1:], dtype=src.dtype)
    return out.index_add_(0, seg, src)
def _pad(x, pw):
    flat = tuple(v for pair in reversed(pw) for v in pair)
    return torch.nn.functional.pad(x, flat)

kernel_name = 'sequential_preLN__sliding_block__dense_activation_gelu__prompt'

def setup_inputs():

    _w = (lambda a: (lambda t: t.to(torch.bfloat16) if t.is_floating_point() else t)(torch.as_tensor(a)))
    def _A_setup():
        B, S, D = 1, 2048, 512
        return {
            "x": _w((lambda *s: torch.randn(*s, dtype=torch.bfloat16) * 0.05)(B, S, D)),
            "wqkv": _w((lambda *s: torch.randn(*s, dtype=torch.bfloat16) * 0.05)(D, 3 * D)),
            "wo": _w((lambda *s: torch.randn(*s, dtype=torch.bfloat16) * 0.05)(D, D)),
        }
    _A_in = _A_setup()

    def _B_setup():
        B, S, D, F = 1, 2048, 512, 1376
        return {
            "x": _w((lambda *s: torch.randn(*s, dtype=torch.bfloat16) * 0.05)(B, S, D)),
            "w1": _w((lambda *s: torch.randn(*s, dtype=torch.bfloat16) * 0.8)(D, F) * (D ** -0.5)),
            "b1": _w((lambda *s: torch.randn(*s, dtype=torch.bfloat16) * 0.8)(F) * 0.01),
            "w2": _w((lambda *s: torch.randn(*s, dtype=torch.bfloat16) * 0.8)(F, D) * (F ** -0.5)),
            "b2": _w((lambda *s: torch.randn(*s, dtype=torch.bfloat16) * 0.8)(D) * 0.01),
        }
    _B_in = _B_setup()

    return {
        "A_x": _A_in["x"],
        "A_wqkv": _A_in["wqkv"],
        "A_wo": _A_in["wo"],
        "B_x": _B_in["x"],
        "B_w1": _B_in["w1"],
        "B_b1": _B_in["b1"],
        "B_w2": _B_in["w2"],
        "B_b2": _B_in["b2"],
    }

def reference(A_x, A_wqkv, A_wo, B_x, B_w1, B_b1, B_w2, B_b2):
    def _A_ref(x, wqkv, wo):
        B, S, D = x.shape
        H = 32; Dh = D // H; W = 256
        qkv = (lambda x, *d: x.permute(*d))((x @ wqkv).reshape(B, S, 3, H, Dh), 2, 0, 3, 1, 4)
        q, k, v = qkv[0], qkv[1], qkv[2]
        scores = torch.einsum("bhqd,bhkd->bhqk", q, k) * (Dh ** -0.5)
        idx = torch.arange(S)
        mask = (idx[:, None] - idx[None, :] >= 0) & (idx[:, None] - idx[None, :] < W)
        scores = torch.where(mask[None, None], scores, -1e9)
        p = _softmax(scores, axis=-1)
        o = torch.einsum("bhqk,bhkd->bhqd", p, v)
        return (lambda x, *d: x.permute(*d))(o, 0, 2, 1, 3).reshape(B, S, D) @ wo

    def _B_ref(x, w1, b1, w2, b2):
        h = torch.einsum("bsd,df->bsf", x, w1) + b1
        h = _gelu(h)
        return torch.einsum("bsf,fd->bsd", h, w2) + b2

    x = A_x
    h = x + _A_ref(_layernorm(x, axis=-1), A_wqkv, A_wo)
    h2 = h + _B_ref(_layernorm(h, axis=-1), B_w1, B_b1, B_w2, B_b2)
    return h2
```

```asm
; @launch grid=(256,1,1) block=(512,1,1) lds=163840
.amdgcn_target "amdgcn-amd-amdhsa--gfx950"
.text
.globl sequential_preLN__sliding_block__dense_activation_gelu__prompt_kernel
.p2align 8
.type sequential_preLN__sliding_block__dense_activation_gelu__prompt_kernel,@function
sequential_preLN__sliding_block__dense_activation_gelu__prompt_kernel:
    s_load_dwordx16 s[16:31], s[0:1], 0
    s_load_dwordx4 s[32:35], s[0:1], 64
    s_load_dwordx2 s[36:37], s[0:1], 80
    s_cmp_ge_u32 s2, 256
    s_cbranch_scc1 L_end_sequential_preLN__sliding_block__dense_activation_gelu__prompt_kernel
    v_and_b32 v1, 63, v0
    v_lshrrev_b32 v2, 6, v0
    s_and_b32 s39, s2, 7
    v_readfirstlane_b32 s38, v2
    s_lshr_b32 s40, s2, 3
    s_waitcnt lgkmcnt(0)
    s_sub_u32 s41, s38, 4
    s_mov_b32 s52, s36
    s_mov_b32 s53, s37
    s_mov_b32 s54, 0x2000000
    s_mov_b32 s55, 0x20000
    s_and_b32 s60, s40, 7
    s_lshr_b32 s62, s39, 1
    s_lshl_b32 s62, s62, 3
    s_add_u32 s60, s60, s62
    s_lshr_b32 s61, s40, 3
    s_and_b32 s62, s39, 1
    s_lshl_b32 s62, s62, 2
    s_add_u32 s61, s61, s62
    s_cmp_lt_u32 s38, 4
    s_cbranch_scc1 P1C_3
    s_mov_b32 s44, s16
    s_mov_b32 s45, s17
    s_mov_b32 s46, 0x200000
    s_mov_b32 s47, 0x20000
    s_mov_b32 s48, s18
    s_mov_b32 s49, s19
    s_mov_b32 s50, 0x180000
    s_mov_b32 s51, 0x20000
    v_lshrrev_b32 v8, 3, v1
    v_and_b32 v9, 7, v1
    v_lshrrev_b32 v10, 4, v1
    v_xor_b32 v11, v9, v10
    v_lshlrev_b32 v11, 4, v11
    v_lshl_add_u32 v2, v8, 10, v11
    v_and_b32 v10, 1, v10
    v_lshlrev_b32 v10, 2, v10
    v_xor_b32 v11, v9, v10
    v_lshlrev_b32 v11, 4, v11
    v_lshl_add_u32 v5, v8, 10, v11
    v_mul_u32_u24 v4, 3072, v8
    v_add_u32 v4, v4, v11
    s_lshr_b32 s74, s40, 3
    s_lshl_b32 s74, s74, 1
    s_add_u32 s76, s74, s40
    s_and_b32 s76, s76, 7
    s_lshl_b32 s74, s76, 7
    v_add_u32 v2, s74, v2
    v_xor_b32 v3, 64, v2
    s_mul_i32 s74, s76, 196608
    v_add_u32 v4, s74, v4
    s_lshl_b32 s62, s60, 6
    s_lshl_b32 s74, s41, 4
    s_add_u32 s62, s62, s74
    s_lshl_b32 s62, s62, 10
    s_add_u32 s63, s62, 8192
    s_lshl_b32 s70, s41, 11
    s_mov_b32 s72, 0
    s_mov_b32 s79, 0xfffffc80
    s_mov_b32 s80, 0xffeb0000
    s_mul_i32 s74, s41, 6
    s_add_u32 s74, s74, 0
    s_and_b32 s75, s74, 7
    s_mul_i32 s75, s75, 24576
    s_lshr_b32 s74, s74, 3
    s_lshl_b32 s74, s74, 10
    s_add_u32 s75, s75, s74
    s_lshl_b32 s74, s61, 7
    s_add_u32 s64, s75, s74
    s_mul_i32 s74, s41, 6
    s_add_u32 s74, s74, 1
    s_and_b32 s75, s74, 7
    s_mul_i32 s75, s75, 24576
    s_lshr_b32 s74, s74, 3
    s_lshl_b32 s74, s74, 10
    s_add_u32 s75, s75, s74
    s_lshl_b32 s74, s61, 7
    s_add_u32 s65, s75, s74
    s_mul_i32 s74, s41, 6
    s_add_u32 s74, s74, 2
    s_and_b32 s75, s74, 7
    s_mul_i32 s75, s75, 24576
    s_lshr_b32 s74, s74, 3
    s_lshl_b32 s74, s74, 10
    s_add_u32 s75, s75, s74
    s_lshl_b32 s74, s61, 7
    s_add_u32 s66, s75, s74
    s_mul_i32 s74, s41, 6
    s_add_u32 s74, s74, 3
    s_and_b32 s75, s74, 7
    s_mul_i32 s75, s75, 24576
    s_lshr_b32 s74, s74, 3
    s_lshl_b32 s74, s74, 10
    s_add_u32 s75, s75, s74
    s_lshl_b32 s74, s61, 7
    s_add_u32 s67, s75, s74
    s_mul_i32 s74, s41, 6
    s_add_u32 s74, s74, 4
    s_and_b32 s75, s74, 7
    s_mul_i32 s75, s75, 24576
    s_lshr_b32 s74, s74, 3
    s_lshl_b32 s74, s74, 10
    s_add_u32 s75, s75, s74
    s_lshl_b32 s74, s61, 7
    s_add_u32 s68, s75, s74
    s_mul_i32 s74, s41, 6
    s_add_u32 s74, s74, 5
    s_and_b32 s75, s74, 7
    s_mul_i32 s75, s75, 24576
    s_lshr_b32 s74, s74, 3
    s_lshl_b32 s74, s74, 10
    s_add_u32 s75, s75, s74
    s_lshl_b32 s74, s61, 7
    s_add_u32 s69, s75, s74
    s_mul_i32 s71, s41, 6144
    s_add_u32 s71, s71, 8192
    s_mov_b32 s73, 0
P1HP_4:
    s_add_u32 m0, s72, s70
    s_nop 0
    buffer_load_dwordx4 v2, s[44:47], s62 offen lds
    s_add_u32 m0, m0, 1024
    s_nop 0
    buffer_load_dwordx4 v3, s[44:47], s63 offen lds
    s_add_u32 m0, s72, s71
    s_nop 0
    buffer_load_dwordx4 v4, s[48:51], s64 offen lds
    s_add_u32 m0, m0, 1024
    s_nop 0
    buffer_load_dwordx4 v4, s[48:51], s65 offen lds
    s_add_u32 m0, m0, 1024
    s_nop 0
    buffer_load_dwordx4 v4, s[48:51], s66 offen lds
    s_add_u32 m0, m0, 1024
    s_nop 0
    buffer_load_dwordx4 v4, s[48:51], s67 offen lds
    s_add_u32 m0, m0, 1024
    s_nop 0
    buffer_load_dwordx4 v4, s[48:51], s68 offen lds
    s_add_u32 m0, m0, 1024
    s_nop 0
    buffer_load_dwordx4 v4, s[48:51], s69 offen lds
    s_cmp_eq_u32 s76, 7
    s_cselect_b32 s77, s79, 128
    s_cselect_b32 s78, s80, 196608
    s_add_u32 s76, s76, 1
    s_and_b32 s76, s76, 7
    v_add_u32 v2, s77, v2
    v_add_u32 v3, s77, v3
    v_add_u32 v4, s78, v4
    s_add_u32 s72, s72, 32768
    s_and_b32 s72, s72, 0x1ffff
    s_add_u32 s73, s73, 1
    s_cmp_lt_u32 s73, 3
    s_cbranch_scc1 P1HP_4
    v_lshrrev_b32 v32, 2, v1
    v_lshlrev_b32 v32, 7, v32
    v_and_b32 v24, 3, v1
    v_lshl_add_u32 v32, v24, 4, v32
    v_add_u32 v32, s70, v32
    s_mov_b32 s81, 0
    v_mov_b32 v28, 0
    v_mov_b32 v29, 0
    v_mov_b32 v30, 0
    v_mov_b32 v31, 0
    s_waitcnt vmcnt(16)
    s_barrier
    v_add_u32 v33, s81, v32
    ds_read_b128 v[16:19], v33
    ds_read_b128 v[20:23], v33 offset:64
    s_add_u32 s81, s81, 32768
    s_and_b32 s81, s81, 0x1ffff
    s_waitcnt lgkmcnt(0)
    v_lshlrev_b32 v24, 16, v16
    v_and_b32 v25, 0xffff0000, v16
    v_add_f32 v28, v28, v24
    v_add_f32 v29, v29, v25
    v_fma_f32 v30, v24, v24, v30
    v_fma_f32 v31, v25, v25, v31
    v_lshlrev_b32 v26, 16, v17
    v_and_b32 v27, 0xffff0000, v17
    v_add_f32 v28, v28, v26
    v_add_f32 v29, v29, v27
    v_fma_f32 v30, v26, v26, v30
    v_fma_f32 v31, v27, v27, v31
    v_lshlrev_b32 v24, 16, v18
    v_and_b32 v25, 0xffff0000, v18
    v_add_f32 v28, v28, v24
    v_add_f32 v29, v29, v25
    v_fma_f32 v30, v24, v24, v30
    v_fma_f32 v31, v25, v25, v31
    v_lshlrev_b32 v26, 16, v19
    v_and_b32 v27, 0xffff0000, v19
    v_add_f32 v28, v28, v26
    v_add_f32 v29, v29, v27
    v_fma_f32 v30, v26, v26, v30
    v_fma_f32 v31, v27, v27, v31
    v_lshlrev_b32 v24, 16, v20
    v_and_b32 v25, 0xffff0000, v20
    v_add_f32 v28, v28, v24
    v_add_f32 v29, v29, v25
    v_fma_f32 v30, v24, v24, v30
    v_fma_f32 v31, v25, v25, v31
    v_lshlrev_b32 v26, 16, v21
    v_and_b32 v27, 0xffff0000, v21
    v_add_f32 v28, v28, v26
    v_add_f32 v29, v29, v27
    v_fma_f32 v30, v26, v26, v30
    v_fma_f32 v31, v27, v27, v31
    v_lshlrev_b32 v24, 16, v22
    v_and_b32 v25, 0xffff0000, v22
    v_add_f32 v28, v28, v24
    v_add_f32 v29, v29, v25
    v_fma_f32 v30, v24, v24, v30
    v_fma_f32 v31, v25, v25, v31
    v_lshlrev_b32 v26, 16, v23
    v_and_b32 v27, 0xffff0000, v23
    v_add_f32 v28, v28, v26
    v_add_f32 v29, v29, v27
    v_fma_f32 v30, v26, v26, v30
    v_fma_f32 v31, v27, v27, v31
    s_mov_b32 s73, 0
P1HL_5:
    s_waitcnt vmcnt(8)
    s_barrier
    v_add_u32 v33, s81, v32
    ds_read_b128 v[16:19], v33
    ds_read_b128 v[20:23], v33 offset:64
    s_add_u32 s81, s81, 32768
    s_and_b32 s81, s81, 0x1ffff
    s_add_u32 m0, s72, s70
    s_nop 0
    buffer_load_dwordx4 v2, s[44:47], s62 offen lds
    s_add_u32 m0, m0, 1024
    s_nop 0
    buffer_load_dwordx4 v3, s[44:47], s63 offen lds
    s_waitcnt lgkmcnt(0)
    v_lshlrev_b32 v24, 16, v16
    v_and_b32 v25, 0xffff0000, v16
    v_add_f32 v28, v28, v24
    v_add_f32 v29, v29, v25
    v_fma_f32 v30, v24, v24, v30
    v_fma_f32 v31, v25, v25, v31
    s_add_u32 m0, s72, s71
    s_nop 0
    buffer_load_dwordx4 v4, s[48:51], s64 offen lds
    v_lshlrev_b32 v26, 16, v17
    v_and_b32 v27, 0xffff0000, v17
    v_add_f32 v28, v28, v26
    v_add_f32 v29, v29, v27
    v_fma_f32 v30, v26, v26, v30
    v_fma_f32 v31, v27, v27, v31
    s_add_u32 m0, m0, 1024
    s_nop 0
    buffer_load_dwordx4 v4, s[48:51], s65 offen lds
    v_lshlrev_b32 v24, 16, v18
    v_and_b32 v25, 0xffff0000, v18
    v_add_f32 v28, v28, v24
    v_add_f32 v29, v29, v25
    v_fma_f32 v30, v24, v24, v30
    v_fma_f32 v31, v25, v25, v31
    s_add_u32 m0, m0, 1024
    s_nop 0
    buffer_load_dwordx4 v4, s[48:51], s66 offen lds
    v_lshlrev_b32 v26, 16, v19
    v_and_b32 v27, 0xffff0000, v19
    v_add_f32 v28, v28, v26
    v_add_f32 v29, v29, v27
    v_fma_f32 v30, v26, v26, v30
    v_fma_f32 v31, v27, v27, v31
    s_add_u32 m0, m0, 1024
    s_nop 0
    buffer_load_dwordx4 v4, s[48:51], s67 offen lds
    v_lshlrev_b32 v24, 16, v20
    v_and_b32 v25, 0xffff0000, v20
    v_add_f32 v28, v28, v24
    v_add_f32 v29, v29, v25
    v_fma_f32 v30, v24, v24, v30
    v_fma_f32 v31, v25, v25, v31
    s_add_u32 m0, m0, 1024
    s_nop 0
    buffer_load_dwordx4 v4, s[48:51], s68 offen lds
    v_lshlrev_b32 v26, 16, v21
    v_and_b32 v27, 0xffff0000, v21
    v_add_f32 v28, v28, v26
    v_add_f32 v29, v29, v27
    v_fma_f32 v30, v26, v26, v30
    v_fma_f32 v31, v27, v27, v31
    s_add_u32 m0, m0, 1024
    s_nop 0
    buffer_load_dwordx4 v4, s[48:51], s69 offen lds
    v_lshlrev_b32 v24, 16, v22
    v_and_b32 v25, 0xffff0000, v22
    v_add_f32 v28, v28, v24
    v_add_f32 v29, v29, v25
    v_fma_f32 v30, v24, v24, v30
    v_fma_f32 v31, v25, v25, v31
    v_lshlrev_b32 v26, 16, v23
    v_and_b32 v27, 0xffff0000, v23
    v_add_f32 v28, v28, v26
    v_add_f32 v29, v29, v27
    v_fma_f32 v30, v26, v26, v30
    v_fma_f32 v31, v27, v27, v31
    s_cmp_eq_u32 s76, 7
    s_cselect_b32 s77, s79, 128
    s_cselect_b32 s78, s80, 196608
    s_add_u32 s76, s76, 1
    s_and_b32 s76, s76, 7
    v_add_u32 v2, s77, v2
    v_add_u32 v3, s77, v3
    v_add_u32 v4, s78, v4
    s_add_u32 s72, s72, 32768
    s_and_b32 s72, s72, 0x1ffff
    s_add_u32 s73, s73, 1
    s_cmp_lt_u32 s73, 5
    s_cbranch_scc1 P1HL_5
    s_waitcnt vmcnt(8)
    s_barrier
    v_add_u32 v33, s81, v32
    ds_read_b128 v[16:19], v33
    ds_read_b128 v[20:23], v33 offset:64
    s_add_u32 s81, s81, 32768
    s_and_b32 s81, s81, 0x1ffff
    s_mov_b32 s56, s20
    s_mov_b32 s57, s21
    s_mov_b32 s58, 0x80000
    s_mov_b32 s59, 0x20000
    s_lshl_b32 s82, s41, 16
    s_lshr_b32 s83, s40, 2
    s_lshl_b32 s83, s83, 7
    s_add_u32 s82, s82, s83
    s_lshl_b32 s83, s41, 13
    s_and_b32 s85, s40, 3
    s_lshl_b32 s85, s85, 11
    s_add_u32 s86, s85, 0
    s_and_b32 s86, s86, 7168
    s_add_u32 m0, s83, s86
    s_lshl_b32 s86, s86, 3
    s_add_u32 s84, s82, s86
    buffer_load_dwordx4 v5, s[56:59], s84 offen lds
    s_add_u32 s86, s85, 1024
    s_and_b32 s86, s86, 7168
    s_add_u32 m0, s83, s86
    s_lshl_b32 s86, s86, 3
    s_add_u32 s84, s82, s86
    buffer_load_dwordx4 v5, s[56:59], s84 offen lds
    s_waitcnt lgkmcnt(0)
    v_lshlrev_b32 v24, 16, v16
    v_and_b32 v25, 0xffff0000, v16
    v_add_f32 v28, v28, v24
    v_add_f32 v29, v29, v25
    v_fma_f32 v30, v24, v24, v30
    v_fma_f32 v31, v25, v25, v31
    s_add_u32 s86, s85, 2048
    s_and_b32 s86, s86, 7168
    s_add_u32 m0, s83, s86
    s_lshl_b32 s86, s86, 3
    s_add_u32 s84, s82, s86
    buffer_load_dwordx4 v5, s[56:59], s84 offen lds
    v_lshlrev_b32 v26, 16, v17
    v_and_b32 v27, 0xffff0000, v17
    v_add_f32 v28, v28, v26
    v_add_f32 v29, v29, v27
    v_fma_f32 v30, v26, v26, v30
    v_fma_f32 v31, v27, v27, v31
    s_add_u32 s86, s85, 3072
    s_and_b32 s86, s86, 7168
    s_add_u32 m0, s83, s86
    s_lshl_b32 s86, s86, 3
    s_add_u32 s84, s82, s86
    buffer_load_dwordx4 v5, s[56:59], s84 offen lds
    v_lshlrev_b32 v24, 16, v18
    v_and_b32 v25, 0xffff0000, v18
    v_add_f32 v28, v28, v24
    v_add_f32 v29, v29, v25
    v_fma_f32 v30, v24, v24, v30
    v_fma_f32 v31, v25, v25, v31
    s_add_u32 s86, s85, 4096
    s_and_b32 s86, s86, 7168
    s_add_u32 m0, s83, s86
    s_lshl_b32 s86, s86, 3
    s_add_u32 s84, s82, s86
    buffer_load_dwordx4 v5, s[56:59], s84 offen lds
    v_lshlrev_b32 v26, 16, v19
    v_and_b32 v27, 0xffff0000, v19
    v_add_f32 v28, v28, v26
    v_add_f32 v29, v29, v27
    v_fma_f32 v30, v26, v26, v30
    v_fma_f32 v31, v27, v27, v31
    s_add_u32 s86, s85, 5120
    s_and_b32 s86, s86, 7168
    s_add_u32 m0, s83, s86
    s_lshl_b32 s86, s86, 3
    s_add_u32 s84, s82, s86
    buffer_load_dwordx4 v5, s[56:59], s84 offen lds
    v_lshlrev_b32 v24, 16, v20
    v_and_b32 v25, 0xffff0000, v20
    v_add_f32 v28, v28, v24
    v_add_f32 v29, v29, v25
    v_fma_f32 v30, v24, v24, v30
    v_fma_f32 v31, v25, v25, v31
    s_add_u32 s86, s85, 6144
    s_and_b32 s86, s86, 7168
    s_add_u32 m0, s83, s86
    s_lshl_b32 s86, s86, 3
    s_add_u32 s84, s82, s86
    buffer_load_dwordx4 v5, s[56:59], s84 offen lds
    v_lshlrev_b32 v26, 16, v21
    v_and_b32 v27, 0xffff0000, v21
    v_add_f32 v28, v28, v26
    v_add_f32 v29, v29, v27
    v_fma_f32 v30, v26, v26, v30
    v_fma_f32 v31, v27, v27, v31
    s_add_u32 s86, s85, 7168
    s_and_b32 s86, s86, 7168
    s_add_u32 m0, s83, s86
    s_lshl_b32 s86, s86, 3
    s_add_u32 s84, s82, s86
    buffer_load_dwordx4 v5, s[56:59], s84 offen lds
    v_lshlrev_b32 v24, 16, v22
    v_and_b32 v25, 0xffff0000, v22
    v_add_f32 v28, v28, v24
    v_add_f32 v29, v29, v25
    v_fma_f32 v30, v24, v24, v30
    v_fma_f32 v31, v25, v25, v31
    v_lshlrev_b32 v26, 16, v23
    v_and_b32 v27, 0xffff0000, v23
    v_add_f32 v28, v28, v26
    v_add_f32 v29, v29, v27
    v_fma_f32 v30, v26, v26, v30
    v_fma_f32 v31, v27, v27, v31
    s_waitcnt vmcnt(8)
    s_barrier
    v_add_u32 v33, s81, v32
    ds_read_b128 v[16:19], v33
    ds_read_b128 v[20:23], v33 offset:64
    s_add_u32 s81, s81, 32768
    s_and_b32 s81, s81, 0x1ffff
    s_add_u32 s86, s85, 0
    s_and_b32 s86, s86, 7168
    s_add_u32 m0, s83, s86
    s_lshl_b32 s86, s86, 3
    s_add_u32 s84, s82, s86
    s_add_u32 m0, m0, 32768
    s_add_u32 s84, s84, 262144
    buffer_load_dwordx4 v5, s[56:59], s84 offen lds
    s_add_u32 s86, s85, 1024
    s_and_b32 s86, s86, 7168
    s_add_u32 m0, s83, s86
    s_lshl_b32 s86, s86, 3
    s_add_u32 s84, s82, s86
    s_add_u32 m0, m0, 32768
    s_add_u32 s84, s84, 262144
    buffer_load_dwordx4 v5, s[56:59], s84 offen lds
    s_waitcnt lgkmcnt(0)
    v_lshlrev_b32 v24, 16, v16
    v_and_b32 v25, 0xffff0000, v16
    v_add_f32 v28, v28, v24
    v_add_f32 v29, v29, v25
    v_fma_f32 v30, v24, v24, v30
    v_fma_f32 v31, v25, v25, v31
    s_add_u32 s86, s85, 2048
    s_and_b32 s86, s86, 7168
    s_add_u32 m0, s83, s86
    s_lshl_b32 s86, s86, 3
    s_add_u32 s84, s82, s86
    s_add_u32 m0, m0, 32768
    s_add_u32 s84, s84, 262144
    buffer_load_dwordx4 v5, s[56:59], s84 offen lds
    v_lshlrev_b32 v26, 16, v17
    v_and_b32 v27, 0xffff0000, v17
    v_add_f32 v28, v28, v26
    v_add_f32 v29, v29, v27
    v_fma_f32 v30, v26, v26, v30
    v_fma_f32 v31, v27, v27, v31
    s_add_u32 s86, s85, 3072
    s_and_b32 s86, s86, 7168
    s_add_u32 m0, s83, s86
    s_lshl_b32 s86, s86, 3
    s_add_u32 s84, s82, s86
    s_add_u32 m0, m0, 32768
    s_add_u32 s84, s84, 262144
    buffer_load_dwordx4 v5, s[56:59], s84 offen lds
    v_lshlrev_b32 v24, 16, v18
    v_and_b32 v25, 0xffff0000, v18
    v_add_f32 v28, v28, v24
    v_add_f32 v29, v29, v25
    v_fma_f32 v30, v24, v24, v30
    v_fma_f32 v31, v25, v25, v31
    s_add_u32 s86, s85, 4096
    s_and_b32 s86, s86, 7168
    s_add_u32 m0, s83, s86
    s_lshl_b32 s86, s86, 3
    s_add_u32 s84, s82, s86
    s_add_u32 m0, m0, 32768
    s_add_u32 s84, s84, 262144
    buffer_load_dwordx4 v5, s[56:59], s84 offen lds
    v_lshlrev_b32 v26, 16, v19
    v_and_b32 v27, 0xffff0000, v19
    v_add_f32 v28, v28, v26
    v_add_f32 v29, v29, v27
    v_fma_f32 v30, v26, v26, v30
    v_fma_f32 v31, v27, v27, v31
    s_add_u32 s86, s85, 5120
    s_and_b32 s86, s86, 7168
    s_add_u32 m0, s83, s86
    s_lshl_b32 s86, s86, 3
    s_add_u32 s84, s82, s86
    s_add_u32 m0, m0, 32768
    s_add_u32 s84, s84, 262144
    buffer_load_dwordx4 v5, s[56:59], s84 offen lds
    v_lshlrev_b32 v24, 16, v20
    v_and_b32 v25, 0xffff0000, v20
    v_add_f32 v28, v28, v24
    v_add_f32 v29, v29, v25
    v_fma_f32 v30, v24, v24, v30
    v_fma_f32 v31, v25, v25, v31
    s_add_u32 s86, s85, 6144
    s_and_b32 s86, s86, 7168
    s_add_u32 m0, s83, s86
    s_lshl_b32 s86, s86, 3
    s_add_u32 s84, s82, s86
    s_add_u32 m0, m0, 32768
    s_add_u32 s84, s84, 262144
    buffer_load_dwordx4 v5, s[56:59], s84 offen lds
    v_lshlrev_b32 v26, 16, v21
    v_and_b32 v27, 0xffff0000, v21
    v_add_f32 v28, v28, v26
    v_add_f32 v29, v29, v27
    v_fma_f32 v30, v26, v26, v30
    v_fma_f32 v31, v27, v27, v31
    s_add_u32 s86, s85, 7168
    s_and_b32 s86, s86, 7168
    s_add_u32 m0, s83, s86
    s_lshl_b32 s86, s86, 3
    s_add_u32 s84, s82, s86
    s_add_u32 m0, m0, 32768
    s_add_u32 s84, s84, 262144
    buffer_load_dwordx4 v5, s[56:59], s84 offen lds
    v_lshlrev_b32 v24, 16, v22
    v_and_b32 v25, 0xffff0000, v22
    v_add_f32 v28, v28, v24
    v_add_f32 v29, v29, v25
    v_fma_f32 v30, v24, v24, v30
    v_fma_f32 v31, v25, v25, v31
    v_lshlrev_b32 v26, 16, v23
    v_and_b32 v27, 0xffff0000, v23
    v_add_f32 v28, v28, v26
    v_add_f32 v29, v29, v27
    v_fma_f32 v30, v26, v26, v30
    v_fma_f32 v31, v27, v27, v31
    v_add_f32 v28, v28, v29
    v_add_f32 v30, v30, v31
    s_nop 1
    v_add_f32_dpp v28, v28, v28 quad_perm:[1,0,3,2] row_mask:0xf bank_mask:0xf
    v_add_f32_dpp v30, v30, v30 quad_perm:[1,0,3,2] row_mask:0xf bank_mask:0xf
    s_nop 1
    v_add_f32_dpp v28, v28, v28 quad_perm:[2,3,0,1] row_mask:0xf bank_mask:0xf
    v_add_f32_dpp v30, v30, v30 quad_perm:[2,3,0,1] row_mask:0xf bank_mask:0xf
    s_nop 1
    v_mul_f32 v28, 0x3b000000, v28
    v_mul_f32 v29, 0x3b000000, v30
    v_fma_f32 v29, -v28, v28, v29
    v_add_f32 v29, 0x3727c5ac, v29
    v_rsq_f32 v29, v29
    s_nop 0
    v_mul_f32 v28, v28, v29
    v_lshrrev_b32 v24, 2, v1
    s_lshl_b32 s84, s41, 6
    s_add_u32 s84, s84, 132608
    v_lshl_add_u32 v24, v24, 2, s84
    ds_write_b32 v24, v29
    ds_write_b32 v24, v28 offset:256
    s_waitcnt lgkmcnt(0)
    s_barrier
    s_barrier
    s_branch P1D_2
P1C_3:
    v_mov_b32 v103, 0
    s_or_b32 s66, s2, s38
    s_cmp_lg_u32 s66, 0
    s_cbranch_scc1 P1E_6
    s_mov_b32 s66, 0x1110000
    buffer_load_dword v104, off, s[52:55], s66 sc1
    s_waitcnt vmcnt(0)
    v_add_u32 v104, 1, v104
    v_mov_b32 v106, 0x9e3779b1
    v_mul_lo_u32 v105, v104, v106
    v_or_b32 v105, 1, v105
    global_store_dword v103, v105, s[34:35] sc1
    buffer_store_dword v104, off, s[52:55], s66 sc1
P1E_6:
    s_and_b32 s62, s38, 1
    s_lshr_b32 s63, s38, 1
    v_and_b32 v104, 31, v1
    v_lshrrev_b32 v105, 5, v1
    s_lshl_b32 s66, s62, 5
    v_add_u32 v106, s66, v104
    v_lshrrev_b32 v107, 1, v106
    v_and_b32 v107, 7, v107
    v_xor_b32 v107, v107, v105
    v_lshlrev_b32 v107, 4, v107
    v_lshlrev_b32 v106, 7, v106
    v_add_u32 v88, v106, v107
    v_xor_b32 v89, 32, v88
    v_xor_b32 v90, 64, v88
    v_xor_b32 v91, 96, v88
    v_and_b32 v106, 15, v1
    v_lshrrev_b32 v107, 2, v106
    v_lshl_add_u32 v107, v105, 3, v107
    v_lshlrev_b32 v107, 7, v107
    v_lshrrev_b32 v108, 3, v106
    v_xor_b32 v108, s63, v108
    v_lshl_add_u32 v107, v108, 6, v107
    v_bfe_u32 v108, v1, 4, 1
    v_lshl_add_u32 v107, v108, 5, v107
    v_and_b32 v108, 3, v106
    v_lshl_add_u32 v107, v108, 3, v107
    v_add_u32 v93, 8192, v107
    v_mov_b32 v94, 0x3f803f80
    s_lshl_b32 s66, s38, 2
    s_add_u32 s66, s66, 133120
    v_mov_b32 v109, s66
    ds_write_b32 v109, v103
    v_mov_b32 v2, 0
    v_mov_b32 v3, 0
    v_mov_b32 v4, 0
    v_mov_b32 v5, 0
    v_mov_b32 v6, 0
    v_mov_b32 v7, 0
    v_mov_b32 v8, 0
    v_mov_b32 v9, 0
    v_mov_b32 v10, 0
    v_mov_b32 v11, 0
    v_mov_b32 v12, 0
    v_mov_b32 v13, 0
    v_mov_b32 v14, 0
    v_mov_b32 v15, 0
    v_mov_b32 v16, 0
    v_mov_b32 v17, 0
    v_mov_b32 v18, 0
    v_mov_b32 v19, 0
    v_mov_b32 v20, 0
    v_mov_b32 v21, 0
    v_mov_b32 v22, 0
    v_mov_b32 v23, 0
    v_mov_b32 v24, 0
    v_mov_b32 v25, 0
    v_mov_b32 v26, 0
    v_mov_b32 v27, 0
    v_mov_b32 v28, 0
    v_mov_b32 v29, 0
    v_mov_b32 v30, 0
    v_mov_b32 v31, 0
    v_mov_b32 v32, 0
    v_mov_b32 v33, 0
    v_mov_b32 v34, 0
    v_mov_b32 v35, 0
    v_mov_b32 v36, 0
    v_mov_b32 v37, 0
    v_mov_b32 v38, 0
    v_mov_b32 v39, 0
    v_mov_b32 v40, 0
    v_mov_b32 v41, 0
    v_mov_b32 v42, 0
    v_mov_b32 v43, 0
    v_mov_b32 v44, 0
    v_mov_b32 v45, 0
    v_mov_b32 v46, 0
    v_mov_b32 v47, 0
    v_mov_b32 v48, 0
    v_mov_b32 v49, 0
    v_mov_b32 v98, 0
    v_mov_b32 v99, 0
    v_mov_b32 v100, 0
    s_mov_b32 s64, 0
    s_mov_b32 s65, 0
    s_waitcnt lgkmcnt(0)
    s_barrier
    ds_read_b128 v[52:55], v88
    ds_read_b64_tr_b16 v[60:61], v93 offset:0
    ds_read_b64_tr_b16 v[62:63], v93 offset:512
    ds_read_b64_tr_b16 v[64:65], v93 offset:8192
    ds_read_b64_tr_b16 v[66:67], v93 offset:8704
    ds_read_b64_tr_b16 v[68:69], v93 offset:16384
    ds_read_b64_tr_b16 v[70:71], v93 offset:16896
    ds_read_b128 v[56:59], v89
    ds_read_b64_tr_b16 v[72:73], v93 offset:2048
    ds_read_b64_tr_b16 v[74:75], v93 offset:2560
    ds_read_b64_tr_b16 v[76:77], v93 offset:10240
    ds_read_b64_tr_b16 v[78:79], v93 offset:10752
    ds_read_b64_tr_b16 v[80:81], v93 offset:18432
    ds_read_b64_tr_b16 v[82:83], v93 offset:18944
P1L_7:
    v_add_u32 v86, s64, v90
    v_add_u32 v87, s64, v91
    v_add_u32 v92, s64, v93
    s_add_u32 s64, s64, 32768
    s_and_b32 s64, s64, 0x1ffff
    v_add_u32 v95, s64, v88
    v_add_u32 v160, s64, v89
    v_add_u32 v101, s64, v93
    s_waitcnt lgkmcnt(7)
    v_mfma_f32_32x32x16_bf16 v[2:17], v[60:63], v[52:55], v[2:17]
    ds_read_b128 v[128:131], v86
    ds_read_b64_tr_b16 v[136:137], v92 offset:4096
    ds_read_b64_tr_b16 v[138:139], v92 offset:4608
    v_mfma_f32_32x32x16_bf16 v[18:33], v[64:67], v[52:55], v[18:33]
    ds_read_b64_tr_b16 v[140:141], v92 offset:12288
    ds_read_b64_tr_b16 v[142:143], v92 offset:12800
    v_mfma_f32_32x32x16_bf16 v[34:49], v[52:55], v[68:71], v[34:49]
    ds_read_b64_tr_b16 v[144:145], v92 offset:20480
    ds_read_b64_tr_b16 v[146:147], v92 offset:20992
    s_cmp_lg_u32 s62, 0
    s_cbranch_scc1 P1s_8
    v_dot2c_f32_bf16 v98, v94, v60
    v_dot2c_f32_bf16 v99, v94, v64
    v_dot2c_f32_bf16 v100, v94, v68
    v_dot2c_f32_bf16 v98, v94, v61
    v_dot2c_f32_bf16 v99, v94, v65
    v_dot2c_f32_bf16 v100, v94, v69
    v_dot2c_f32_bf16 v98, v94, v62
    v_dot2c_f32_bf16 v99, v94, v66
    v_dot2c_f32_bf16 v100, v94, v70
    v_dot2c_f32_bf16 v98, v94, v63
    v_dot2c_f32_bf16 v99, v94, v67
    v_dot2c_f32_bf16 v100, v94, v71
P1s_8:
    s_waitcnt lgkmcnt(7)
    v_mfma_f32_32x32x16_bf16 v[2:17], v[72:75], v[56:59], v[2:17]
    ds_read_b128 v[132:135], v87
    ds_read_b64_tr_b16 v[148:149], v92 offset:6144
    ds_read_b64_tr_b16 v[150:151], v92 offset:6656
    v_mfma_f32_32x32x16_bf16 v[18:33], v[76:79], v[56:59], v[18:33]
    ds_read_b64_tr_b16 v[152:153], v92 offset:14336
    ds_read_b64_tr_b16 v[154:155], v92 offset:14848
    v_mfma_f32_32x32x16_bf16 v[34:49], v[56:59], v[80:83], v[34:49]
    ds_read_b64_tr_b16 v[156:157], v92 offset:22528
    ds_read_b64_tr_b16 v[158:159], v92 offset:23040
    s_cmp_lg_u32 s62, 1
    s_cbranch_scc1 P1s_9
    v_dot2c_f32_bf16 v98, v94, v72
    v_dot2c_f32_bf16 v99, v94, v76
    v_dot2c_f32_bf16 v100, v94, v80
    v_dot2c_f32_bf16 v98, v94, v73
    v_dot2c_f32_bf16 v99, v94, v77
    v_dot2c_f32_bf16 v100, v94, v81
    v_dot2c_f32_bf16 v98, v94, v74
    v_dot2c_f32_bf16 v99, v94, v78
    v_dot2c_f32_bf16 v100, v94, v82
    v_dot2c_f32_bf16 v98, v94, v75
    v_dot2c_f32_bf16 v99, v94, v79
    v_dot2c_f32_bf16 v100, v94, v83
P1s_9:
    s_barrier
    s_waitcnt lgkmcnt(7)
    v_mfma_f32_32x32x16_bf16 v[2:17], v[136:139], v[128:131], v[2:17]
    ds_read_b128 v[52:55], v95
    ds_read_b64_tr_b16 v[60:61], v101 offset:0
    ds_read_b64_tr_b16 v[62:63], v101 offset:512
    v_mfma_f32_32x32x16_bf16 v[18:33], v[140:143], v[128:131], v[18:33]
    ds_read_b64_tr_b16 v[64:65], v101 offset:8192
    ds_read_b64_tr_b16 v[66:67], v101 offset:8704
    v_mfma_f32_32x32x16_bf16 v[34:49], v[128:131], v[144:147], v[34:49]
    ds_read_b64_tr_b16 v[68:69], v101 offset:16384
    ds_read_b64_tr_b16 v[70:71], v101 offset:16896
    s_cmp_lg_u32 s62, 0
    s_cbranch_scc1 P1s_10
    v_dot2c_f32_bf16 v98, v94, v136
    v_dot2c_f32_bf16 v99, v94, v140
    v_dot2c_f32_bf16 v100, v94, v144
    v_dot2c_f32_bf16 v98, v94, v137
    v_dot2c_f32_bf16 v99, v94, v141
    v_dot2c_f32_bf16 v100, v94, v145
    v_dot2c_f32_bf16 v98, v94, v138
    v_dot2c_f32_bf16 v99, v94, v142
    v_dot2c_f32_bf16 v100, v94, v146
    v_dot2c_f32_bf16 v98, v94, v139
    v_dot2c_f32_bf16 v99, v94, v143
    v_dot2c_f32_bf16 v100, v94, v147
P1s_10:
    s_waitcnt lgkmcnt(7)
    v_mfma_f32_32x32x16_bf16 v[2:17], v[148:151], v[132:135], v[2:17]
    ds_read_b128 v[56:59], v160
    ds_read_b64_tr_b16 v[72:73], v101 offset:2048
    ds_read_b64_tr_b16 v[74:75], v101 offset:2560
    v_mfma_f32_32x32x16_bf16 v[18:33], v[152:155], v[132:135], v[18:33]
    ds_read_b64_tr_b16 v[76:77], v101 offset:10240
    ds_read_b64_tr_b16 v[78:79], v101 offset:10752
    v_mfma_f32_32x32x16_bf16 v[34:49], v[132:135], v[156:159], v[34:49]
    ds_read_b64_tr_b16 v[80:81], v101 offset:18432
    ds_read_b64_tr_b16 v[82:83], v101 offset:18944
    s_cmp_lg_u32 s62, 1
    s_cbranch_scc1 P1s_11
    v_dot2c_f32_bf16 v98, v94, v148
    v_dot2c_f32_bf16 v99, v94, v152
    v_dot2c_f32_bf16 v100, v94, v156
    v_dot2c_f32_bf16 v98, v94, v149
    v_dot2c_f32_bf16 v99, v94, v153
    v_dot2c_f32_bf16 v100, v94, v157
    v_dot2c_f32_bf16 v98, v94, v150
    v_dot2c_f32_bf16 v99, v94, v154
    v_dot2c_f32_bf16 v100, v94, v158
    v_dot2c_f32_bf16 v98, v94, v151
    v_dot2c_f32_bf16 v99, v94, v155
    v_dot2c_f32_bf16 v100, v94, v159
P1s_11:
    s_add_u32 s65, s65, 1
    s_cmp_lt_u32 s65, 8
    s_cbranch_scc1 P1L_7
    s_cmp_lg_u32 s38, 0
    s_cbranch_scc1 TGW_12
    global_load_dword v102, v103, s[34:35] sc1
TGW_12:
    s_mul_i32 s66, s63, 384
    s_add_u32 s66, s66, 131072
    v_lshl_add_u32 v124, v104, 2, s66
    s_mul_i32 s68, s62, 768
    v_add_u32 v112, s68, v124
    v_mov_b32 v116, v98
    v_mov_b32 v117, v99
    v_mov_b32 v118, v100
    s_nop 0
    v_permlane32_swap_b32 v98, v116
    v_permlane32_swap_b32 v99, v117
    v_permlane32_swap_b32 v100, v118
    s_nop 0
    v_add_f32 v98, v98, v116
    v_add_f32 v99, v99, v117
    v_add_f32 v100, v100, v118
    ds_write_b32 v112, v98 offset:0
    ds_write_b32 v112, v99 offset:128
    ds_write_b32 v112, v100 offset:256
    s_lshl_b32 s66, s60, 1
    s_add_u32 s66, s66, s62
    s_lshl_b32 s67, s61, 2
    s_lshl_b32 s68, s63, 1
    s_add_u32 s67, s67, s68
    s_lshl_b32 s68, s67, 16
    s_lshl_b32 s69, s66, 10
    s_add_u32 s68, s68, s69
    v_lshl_add_u32 v119, v1, 4, s68
    v_lshrrev_b32 v120, 4, v104
    v_lshlrev_b32 v120, 16, v120
    v_lshl_add_u32 v120, v105, 8, v120
    v_and_b32 v121, 15, v104
    v_lshl_add_u32 v120, v121, 4, v120
    v_add_u32 v120, s68, v120
    s_lshr_b32 s70, s60, 2
    s_cmp_lt_u32 s70, 7
    s_cselect_b32 s71, 1, 0
    v_bfe_u32 v127, v1, 2, 1
    v_and_b32 v127, s71, v127
    v_mul_u32_u24 v127, 112, v127
    v_and_b32 v126, 3, v1
    v_lshl_add_u32 v126, v126, 10, v127
    s_lshl_b32 s71, s61, 5
    s_add_u32 s70, s70, s71
    s_lshl_b32 s70, s70, 7
    s_and_b32 s71, s60, 3
    s_lshl_b32 s71, s71, 2
    s_add_u32 s70, s70, s71
    s_add_u32 s70, s70, 16
    v_add_u32 v126, s70, v126
    s_mul_i32 s70, s63, 384
    s_add_u32 s70, s70, 131072
    v_lshl_add_u32 v113, v105, 4, s70
    s_lshl_b32 s71, s62, 7
    s_add_u32 s71, s71, 132608
    v_lshl_add_u32 v114, v105, 4, s71
    v_lshl_add_u32 v115, v104, 2, s71
    s_waitcnt lgkmcnt(0)
    s_barrier
    ds_read_b32 v116, v115
    ds_read_b32 v117, v115 offset:256
    ds_read_b32 v118, v124 offset:256
    ds_read_b32 v125, v124 offset:1024
    ds_read_b128 v[128:131], v113 offset:0
    ds_read_b128 v[132:135], v113 offset:32
    ds_read_b128 v[136:139], v113 offset:64
    ds_read_b128 v[140:143], v113 offset:96
    ds_read_b128 v[216:219], v113 offset:768
    ds_read_b128 v[220:223], v113 offset:800
    ds_read_b128 v[224:227], v113 offset:832
    ds_read_b128 v[228:231], v113 offset:864
    ds_read_b128 v[144:147], v113 offset:128
    ds_read_b128 v[148:151], v113 offset:160
    ds_read_b128 v[152:155], v113 offset:192
    ds_read_b128 v[156:159], v113 offset:224
    ds_read_b128 v[232:235], v113 offset:896
    ds_read_b128 v[236:239], v113 offset:928
    ds_read_b128 v[240:243], v113 offset:960
    ds_read_b128 v[244:247], v113 offset:992
    s_waitcnt lgkmcnt(8)
    v_mul_f32 v52, 0x3eb8aa3b, v116
    v_mul_f32 v54, 0xbeb8aa3b, v117
    v_add_f32 v118, v118, v125
    v_mov_b32 v56, v116
    v_mov_b32 v57, v116
    v_sub_f32 v58, 0, v117
    v_sub_f32 v59, 0, v117
    v_mov_b32 v53, v52
    v_mov_b32 v55, v54
    v_sub_f32 v60, 0, v118
    v_sub_f32 v61, 0, v118
    v_pk_add_f32 v[128:129], v[128:129], v[216:217]
    v_pk_add_f32 v[130:131], v[130:131], v[218:219]
    v_pk_add_f32 v[132:133], v[132:133], v[220:221]
    v_pk_add_f32 v[134:135], v[134:135], v[222:223]
    v_pk_add_f32 v[136:137], v[136:137], v[224:225]
    v_pk_add_f32 v[138:139], v[138:139], v[226:227]
    v_pk_add_f32 v[140:141], v[140:141], v[228:229]
    v_pk_add_f32 v[142:143], v[142:143], v[230:231]
    v_pk_mul_f32 v[128:129], v[128:129], v[54:55]
    v_pk_mul_f32 v[130:131], v[130:131], v[54:55]
    v_pk_mul_f32 v[132:133], v[132:133], v[54:55]
    v_pk_mul_f32 v[134:135], v[134:135], v[54:55]
    v_pk_mul_f32 v[136:137], v[136:137], v[54:55]
    v_pk_mul_f32 v[138:139], v[138:139], v[54:55]
    v_pk_mul_f32 v[140:141], v[140:141], v[54:55]
    v_pk_mul_f32 v[142:143], v[142:143], v[54:55]
    v_pk_fma_f32 v[2:3], v[2:3], v[52:53], v[128:129]
    v_pk_fma_f32 v[4:5], v[4:5], v[52:53], v[130:131]
    v_pk_fma_f32 v[6:7], v[6:7], v[52:53], v[132:133]
    v_pk_fma_f32 v[8:9], v[8:9], v[52:53], v[134:135]
    v_pk_fma_f32 v[10:11], v[10:11], v[52:53], v[136:137]
    v_pk_fma_f32 v[12:13], v[12:13], v[52:53], v[138:139]
    v_pk_fma_f32 v[14:15], v[14:15], v[52:53], v[140:141]
    v_pk_fma_f32 v[16:17], v[16:17], v[52:53], v[142:143]
    v_cvt_pk_bf16_f32 v192, v2, v3
    v_cvt_pk_bf16_f32 v193, v4, v5
    v_cvt_pk_bf16_f32 v194, v6, v7
    v_cvt_pk_bf16_f32 v195, v8, v9
    v_cvt_pk_bf16_f32 v196, v10, v11
    v_cvt_pk_bf16_f32 v197, v12, v13
    v_cvt_pk_bf16_f32 v198, v14, v15
    v_cvt_pk_bf16_f32 v199, v16, v17
    s_mov_b32 s70, 0x0
    s_mov_b32 s71, 0x10000
    buffer_store_dwordx4 v[192:195], v119, s[52:55], s70 offen sc1
    buffer_store_dwordx4 v[196:199], v119, s[52:55], s71 offen sc1
    ds_read_b128 v[160:163], v114 offset:0
    ds_read_b128 v[164:167], v114 offset:32
    ds_read_b128 v[168:171], v114 offset:64
    ds_read_b128 v[172:175], v114 offset:96
    ds_read_b128 v[176:179], v114 offset:256
    ds_read_b128 v[180:183], v114 offset:288
    ds_read_b128 v[184:187], v114 offset:320
    ds_read_b128 v[188:191], v114 offset:352
    s_waitcnt lgkmcnt(8)
    v_pk_add_f32 v[144:145], v[144:145], v[232:233]
    v_pk_add_f32 v[146:147], v[146:147], v[234:235]
    v_pk_add_f32 v[148:149], v[148:149], v[236:237]
    v_pk_add_f32 v[150:151], v[150:151], v[238:239]
    v_pk_add_f32 v[152:153], v[152:153], v[240:241]
    v_pk_add_f32 v[154:155], v[154:155], v[242:243]
    v_pk_add_f32 v[156:157], v[156:157], v[244:245]
    v_pk_add_f32 v[158:159], v[158:159], v[246:247]
    v_pk_mul_f32 v[144:145], v[144:145], v[58:59]
    v_pk_mul_f32 v[146:147], v[146:147], v[58:59]
    v_pk_mul_f32 v[148:149], v[148:149], v[58:59]
    v_pk_mul_f32 v[150:151], v[150:151], v[58:59]
    v_pk_mul_f32 v[152:153], v[152:153], v[58:59]
    v_pk_mul_f32 v[154:155], v[154:155], v[58:59]
    v_pk_mul_f32 v[156:157], v[156:157], v[58:59]
    v_pk_mul_f32 v[158:159], v[158:159], v[58:59]
    v_pk_fma_f32 v[18:19], v[18:19], v[56:57], v[144:145]
    v_pk_fma_f32 v[20:21], v[20:21], v[56:57], v[146:147]
    v_pk_fma_f32 v[22:23], v[22:23], v[56:57], v[148:149]
    v_pk_fma_f32 v[24:25], v[24:25], v[56:57], v[150:151]
    v_pk_fma_f32 v[26:27], v[26:27], v[56:57], v[152:153]
    v_pk_fma_f32 v[28:29], v[28:29], v[56:57], v[154:155]
    v_pk_fma_f32 v[30:31], v[30:31], v[56:57], v[156:157]
    v_pk_fma_f32 v[32:33], v[32:33], v[56:57], v[158:159]
    v_cvt_pk_bf16_f32 v200, v18, v19
    v_cvt_pk_bf16_f32 v201, v20, v21
    v_cvt_pk_bf16_f32 v202, v22, v23
    v_cvt_pk_bf16_f32 v203, v24, v25
    v_cvt_pk_bf16_f32 v204, v26, v27
    v_cvt_pk_bf16_f32 v205, v28, v29
    v_cvt_pk_bf16_f32 v206, v30, v31
    v_cvt_pk_bf16_f32 v207, v32, v33
    s_mov_b32 s70, 0x200000
    s_mov_b32 s71, 0x210000
    buffer_store_dwordx4 v[200:203], v119, s[52:55], s70 offen sc1
    buffer_store_dwordx4 v[204:207], v119, s[52:55], s71 offen sc1
    s_waitcnt lgkmcnt(0)
    v_pk_mul_f32 v[176:177], v[176:177], v[60:61]
    v_pk_mul_f32 v[178:179], v[178:179], v[60:61]
    v_pk_mul_f32 v[180:181], v[180:181], v[60:61]
    v_pk_mul_f32 v[182:183], v[182:183], v[60:61]
    v_pk_mul_f32 v[184:185], v[184:185], v[60:61]
    v_pk_mul_f32 v[186:187], v[186:187], v[60:61]
    v_pk_mul_f32 v[188:189], v[188:189], v[60:61]
    v_pk_mul_f32 v[190:191], v[190:191], v[60:61]
    v_pk_fma_f32 v[34:35], v[34:35], v[160:161], v[176:177]
    v_pk_fma_f32 v[36:37], v[36:37], v[162:163], v[178:179]
    v_pk_fma_f32 v[38:39], v[38:39], v[164:165], v[180:181]
    v_pk_fma_f32 v[40:41], v[40:41], v[166:167], v[182:183]
    v_pk_fma_f32 v[42:43], v[42:43], v[168:169], v[184:185]
    v_pk_fma_f32 v[44:45], v[44:45], v[170:171], v[186:187]
    v_pk_fma_f32 v[46:47], v[46:47], v[172:173], v[188:189]
    v_pk_fma_f32 v[48:49], v[48:49], v[174:175], v[190:191]
    v_cvt_pk_bf16_f32 v208, v34, v35
    v_cvt_pk_bf16_f32 v209, v36, v37
    v_cvt_pk_bf16_f32 v210, v38, v39
    v_cvt_pk_bf16_f32 v211, v40, v41
    v_cvt_pk_bf16_f32 v212, v42, v43
    v_cvt_pk_bf16_f32 v213, v44, v45
    v_cvt_pk_bf16_f32 v214, v46, v47
    v_cvt_pk_bf16_f32 v215, v48, v49
    s_mov_b32 s70, 0x400000
    buffer_store_dwordx4 v[208:211], v120, s[52:55], s70 offen sc1
    buffer_store_dwordx4 v[212:215], v120, s[52:55], s70 offen offset:512 sc1
    s_cmp_lg_u32 s38, 0
    s_cbranch_scc1 TGX_13
    s_waitcnt vmcnt(0)
    s_mov_b32 s43, 300000
TG_15:
    v_readfirstlane_b32 s42, v102
    s_nop 0
    s_cmp_lg_u32 s42, 0
    s_cbranch_scc1 TD_16
    global_load_dword v102, v103, s[34:35] sc1
    s_waitcnt vmcnt(0)
    s_sub_u32 s43, s43, 1
    s_cbranch_scc0 TG_15
TD_16:
    s_branch TGY_14
TGX_13:
    s_waitcnt vmcnt(0)
TGY_14:
    s_lshl_b32 s70, s38, 2
    s_add_u32 s70, s70, 133120
    v_mov_b32 v112, s70
    v_and_b32 v113, 3, v1
    v_lshlrev_b32 v113, 2, v113
    v_add_u32 v113, 133120, v113
    s_mov_b32 s93, 0x7fd0a500
    v_mov_b32 v114, s93
    ds_write_b32 v112, v114
    s_cmp_lg_u32 s38, 0
    s_cbranch_scc1 SD_18
SG_17:
    ds_read_b32 v114, v113
    s_waitcnt lgkmcnt(0)
    v_cmp_ne_u32 vcc, s93, v114
    s_cbranch_vccnz SG_17
    s_cmp_lg_u32 s38, 0
    s_cbranch_scc1 PUB_19
    s_mov_b32 s92, 0x1200000
    v_mov_b32 v114, s42
    buffer_store_dword v114, v126, s[52:55], s92 offen sc1
PUB_19:
SD_18:
P1D_2:
    s_waitcnt lgkmcnt(0)
    s_barrier
    s_lshl_b32 s60, s39, 3
    s_add_u32 s60, s60, s38
    s_mov_b32 s62, s40
    v_and_b32 v48, 7, v1
    s_cmp_eq_u32 s39, 0
    s_cselect_b32 s64, 4, 0
    v_or_b32 v48, s64, v48
    v_lshlrev_b32 v48, 2, v48
    s_lshl_b32 s64, s2, 7
    v_add_u32 v48, s64, v48
    s_lshl_b32 s63, s62, 16
    s_add_u32 s64, s63, 0x200000
    s_add_u32 s44, s36, s64
    s_addc_u32 s45, s37, 0
    s_mov_b32 s46, 0x10000
    s_mov_b32 s47, 0x20000
    s_add_u32 s64, s63, 0x400000
    s_add_u32 s48, s36, s64
    s_addc_u32 s49, s37, 0
    s_mov_b32 s50, 0x10000
    s_mov_b32 s51, 0x20000
    s_lshl_b32 s64, s39, 3
    s_lshl_b32 s65, s38, 1
    s_add_u32 s64, s64, s65
    s_sub_u32 s64, s64, 8
    s_lshl_b32 s64, s64, 10
    v_lshlrev_b32 v236, 4, v1
    v_add_u32 v237, s64, v236
    v_and_b32 v238, 31, v1
    v_lshrrev_b32 v239, 5, v1
    v_lshlrev_b32 v240, 2, v239
    v_sub_u32 v240, v238, v240
    v_mov_b32 v241, 0xf149f2ca
    v_mov_b32 v242, 0
    v_cmp_le_i32 s[64:65], 0, v240
    v_cmp_le_i32 s[66:67], 1, v240
    v_cmp_le_i32 s[68:69], 2, v240
    v_cmp_le_i32 s[70:71], 3, v240
    v_cmp_le_i32 s[72:73], 8, v240
    v_cmp_le_i32 s[74:75], 9, v240
    v_cmp_le_i32 s[76:77], 10, v240
    v_cmp_le_i32 s[78:79], 11, v240
    v_cmp_le_i32 s[80:81], 16, v240
    v_cmp_le_i32 s[82:83], 17, v240
    v_cmp_le_i32 s[84:85], 18, v240
    v_cmp_le_i32 s[86:87], 19, v240
    v_cmp_le_i32 s[88:89], 24, v240
    v_cmp_le_i32 s[90:91], 25, v240
    v_cmp_le_i32 s[92:93], 26, v240
    v_cmp_le_i32 s[94:95], 27, v240
    s_nop 1
    v_cndmask_b32 v204, v241, v242, s[64:65]
    v_cndmask_b32 v188, v242, v241, s[64:65]
    v_cndmask_b32 v205, v241, v242, s[66:67]
    v_cndmask_b32 v189, v242, v241, s[66:67]
    v_cndmask_b32 v206, v241, v242, s[68:69]
    v_cndmask_b32 v190, v242, v241, s[68:69]
    v_cndmask_b32 v207, v241, v242, s[70:71]
    v_cndmask_b32 v191, v242, v241, s[70:71]
    v_cndmask_b32 v208, v241, v242, s[72:73]
    v_cndmask_b32 v192, v242, v241, s[72:73]
    v_cndmask_b32 v209, v241, v242, s[74:75]
    v_cndmask_b32 v193, v242, v241, s[74:75]
    v_cndmask_b32 v210, v241, v242, s[76:77]
    v_cndmask_b32 v194, v242, v241, s[76:77]
    v_cndmask_b32 v211, v241, v242, s[78:79]
    v_cndmask_b32 v195, v242, v241, s[78:79]
    v_cndmask_b32 v212, v241, v242, s[80:81]
    v_cndmask_b32 v196, v242, v241, s[80:81]
    v_cndmask_b32 v213, v241, v242, s[82:83]
    v_cndmask_b32 v197, v242, v241, s[82:83]
    v_cndmask_b32 v214, v241, v242, s[84:85]
    v_cndmask_b32 v198, v242, v241, s[84:85]
    v_cndmask_b32 v215, v241, v242, s[86:87]
    v_cndmask_b32 v199, v242, v241, s[86:87]
    v_cndmask_b32 v216, v241, v242, s[88:89]
    v_cndmask_b32 v200, v242, v241, s[88:89]
    v_cndmask_b32 v217, v241, v242, s[90:91]
    v_cndmask_b32 v201, v242, v241, s[90:91]
    v_cndmask_b32 v218, v241, v242, s[92:93]
    v_cndmask_b32 v202, v242, v241, s[92:93]
    v_cndmask_b32 v219, v241, v242, s[94:95]
    v_cndmask_b32 v203, v242, v241, s[94:95]
    s_lshl_b32 s64, s38, 11
    s_add_u32 s64, s64, 90112
    v_add_u32 v243, s64, v236
    s_mul_i32 s64, s38, 2112
    s_add_u32 s64, s64, 106496
    v_mul_u32_u24 v244, 528, v239
    v_lshl_add_u32 v244, v238, 4, v244
    v_add_u32 v244, s64, v244
    v_mov_b32 v246, 0x3f803f80
    v_mov_b32 v247, 0x3f803f80
    v_mov_b32 v248, 0x3f803f80
    v_mov_b32 v249, 0x3f803f80
    v_mul_u32_u24 v245, 528, v238
    v_add_u32 v245, 107008, v245
    ds_write_b128 v245, v[246:249]
    s_sub_u32 s61, 8, s38
    s_cmp_eq_u32 s39, 0
    s_cselect_b32 s61, s61, 0
    s_lshl_b32 s64, s38, 10
    s_add_u32 s64, s64, 90112
    v_add_u32 v250, s64, v236
    v_lshlrev_b32 v251, 8, v239
    v_lshl_add_u32 v251, v238, 4, v251
    v_cmp_gt_u32 vcc, 16, v238
    v_mov_b32 v245, 512
    s_nop 0
    v_cndmask_b32 v251, v245, v251, vcc
    s_mul_i32 s64, s38, 1056
    s_add_u32 s64, s64, 106496
    v_add_u32 v251, s64, v251
    v_add_u32 v44, 0, v1
    v_mul_u32_u24 v45, 171, v44
    v_lshrrev_b32 v45, 11, v45
    v_mul_u32_u24 v46, 12, v45
    v_sub_u32 v46, v44, v46
    v_mul_u32_u24 v2, 2752, v45
    v_lshl_add_u32 v2, v46, 4, v2
    v_add_u32 v44, 64, v1
    v_mul_u32_u24 v45, 171, v44
    v_lshrrev_b32 v45, 11, v45
    v_mul_u32_u24 v46, 12, v45
    v_sub_u32 v46, v44, v46
    v_mul_u32_u24 v3, 2752, v45
    v_lshl_add_u32 v3, v46, 4, v3
    v_add_u32 v44, 128, v1
    v_mul_u32_u24 v45, 171, v44
    v_lshrrev_b32 v45, 11, v45
    v_mul_u32_u24 v46, 12, v45
    v_sub_u32 v46, v44, v46
    v_mul_u32_u24 v252, 2752, v45
    v_lshl_add_u32 v252, v46, 4, v252
    s_mov_b32 s56, s24
    s_mov_b32 s57, s25
    s_mov_b32 s58, 0x158000
    s_mov_b32 s59, 0x20000
    s_lshr_b32 s64, s38, 2
    s_mul_i32 s64, s64, 24
    s_and_b32 s65, s38, 3
    s_lshl_b32 s65, s65, 1
    s_add_u32 s64, s64, s65
    s_mul_i32 s70, s64, 3072
    s_add_u32 s70, s70, 65536
    s_mul_i32 s71, s64, 44032
    s_lshr_b32 s65, s40, 1
    s_mul_i32 s65, s65, 192
    s_add_u32 s71, s71, s65
    v_lshrrev_b32 v44, 3, v1
    v_and_b32 v45, 7, v1
    v_bfe_u32 v46, v1, 4, 1
    v_lshlrev_b32 v46, 2, v46
    v_xor_b32 v45, v45, v46
    v_lshlrev_b32 v45, 4, v45
    v_mul_u32_u24 v253, 1024, v44
    v_add_u32 v253, v253, v45
    s_waitcnt lgkmcnt(0)
    s_cmp_lg_u32 s38, 0
    s_cbranch_scc1 POD_21
    s_mov_b32 s92, 0x1200000
    s_mov_b32 s43, 300000
POL_20:
    buffer_load_dword v49, v48, s[52:55], s92 offen sc1
    s_waitcnt vmcnt(0)
    v_cmp_ne_u32 vcc, s42, v49
    s_cbranch_vccz POD_21
    s_sub_u32 s43, s43, 1
    s_cbranch_scc0 POL_20
POD_21:
    s_barrier
    buffer_load_dwordx4 v[140:143], v237, s[44:47], 0 offen sc1
    buffer_load_dwordx4 v[144:147], v237, s[44:47], 0 offen offset:1024 sc1
    buffer_load_dwordx4 v[148:151], v237, s[48:51], 0 offen sc1
    buffer_load_dwordx4 v[152:155], v237, s[48:51], 0 offen offset:1024 sc1
    s_lshl_b32 s65, s60, 10
    s_add_u32 s65, s65, s63
    s_add_u32 s66, s65, 0x0
    buffer_load_dwordx4 v[4:7], v236, s[52:55], s66 offen sc1
    s_cmp_eq_u32 s61, 0
    s_cbranch_scc1 P2p_22
    v_mov_b32 v44, v241
    v_mov_b32 v45, v241
    v_mov_b32 v46, v241
    v_mov_b32 v47, v241
    v_mov_b32 v48, v241
    v_mov_b32 v49, v241
    v_mov_b32 v50, v241
    v_mov_b32 v51, v241
    v_mov_b32 v52, v241
    v_mov_b32 v53, v241
    v_mov_b32 v54, v241
    v_mov_b32 v55, v241
    v_mov_b32 v56, v241
    v_mov_b32 v57, v241
    v_mov_b32 v58, v241
    v_mov_b32 v59, v241
    v_mov_b32 v60, v241
    v_mov_b32 v61, v241
    v_mov_b32 v62, v241
    v_mov_b32 v63, v241
    v_mov_b32 v64, v241
    v_mov_b32 v65, v241
    v_mov_b32 v66, v241
    v_mov_b32 v67, v241
    v_mov_b32 v68, v241
    v_mov_b32 v69, v241
    v_mov_b32 v70, v241
    v_mov_b32 v71, v241
    v_mov_b32 v72, v241
    v_mov_b32 v73, v241
    v_mov_b32 v74, v241
    v_mov_b32 v75, v241
    v_mov_b32 v76, v241
    v_mov_b32 v77, v241
    v_mov_b32 v78, v241
    v_mov_b32 v79, v241
    v_mov_b32 v80, v241
    v_mov_b32 v81, v241
    v_mov_b32 v82, v241
    v_mov_b32 v83, v241
    v_mov_b32 v84, v241
    v_mov_b32 v85, v241
    v_mov_b32 v86, v241
    v_mov_b32 v87, v241
    v_mov_b32 v88, v241
    v_mov_b32 v89, v241
    v_mov_b32 v90, v241
    v_mov_b32 v91, v241
    v_mov_b32 v92, v241
    v_mov_b32 v93, v241
    v_mov_b32 v94, v241
    v_mov_b32 v95, v241
    v_mov_b32 v96, v241
    v_mov_b32 v97, v241
    v_mov_b32 v98, v241
    v_mov_b32 v99, v241
    v_mov_b32 v100, v241
    v_mov_b32 v101, v241
    v_mov_b32 v102, v241
    v_mov_b32 v103, v241
    v_mov_b32 v104, v241
    v_mov_b32 v105, v241
    v_mov_b32 v106, v241
    v_mov_b32 v107, v241
    v_mov_b32 v108, v241
    v_mov_b32 v109, v241
    v_mov_b32 v110, v241
    v_mov_b32 v111, v241
    v_mov_b32 v112, v241
    v_mov_b32 v113, v241
    v_mov_b32 v114, v241
    v_mov_b32 v115, v241
    v_mov_b32 v116, v241
    v_mov_b32 v117, v241
    v_mov_b32 v118, v241
    v_mov_b32 v119, v241
    v_mov_b32 v120, v241
    v_mov_b32 v121, v241
    v_mov_b32 v122, v241
    v_mov_b32 v123, v241
    v_mov_b32 v124, v241
    v_mov_b32 v125, v241
    v_mov_b32 v126, v241
    v_mov_b32 v127, v241
    v_mov_b32 v128, v241
    v_mov_b32 v129, v241
    v_mov_b32 v130, v241
    v_mov_b32 v131, v241
    v_mov_b32 v132, v241
    v_mov_b32 v133, v241
    v_mov_b32 v134, v241
    v_mov_b32 v135, v241
    v_mov_b32 v136, v241
    v_mov_b32 v137, v241
    v_mov_b32 v138, v241
    v_mov_b32 v139, v241
    v_mov_b32 v156, v241
    v_mov_b32 v157, v241
    v_mov_b32 v158, v241
    v_mov_b32 v159, v241
    v_mov_b32 v160, v241
    v_mov_b32 v161, v241
    v_mov_b32 v162, v241
    v_mov_b32 v163, v241
    v_mov_b32 v164, v241
    v_mov_b32 v165, v241
    v_mov_b32 v166, v241
    v_mov_b32 v167, v241
    v_mov_b32 v168, v241
    v_mov_b32 v169, v241
    v_mov_b32 v170, v241
    v_mov_b32 v171, v241
P2p_22:
    s_waitcnt vmcnt(3)
    ds_write_b128 v243, v[140:143]
    ds_write_b128 v243, v[144:147] offset:1024
    s_waitcnt vmcnt(1)
    ds_write_b128 v244, v[148:151]
    ds_write_b128 v244, v[152:155] offset:1056
    s_waitcnt lgkmcnt(0)
    s_barrier
    ds_read_b128 v[8:11], v250 offset:0
    ds_read_b128 v[12:15], v250 offset:1024
    ds_read_b128 v[16:19], v250 offset:2048
    ds_read_b128 v[20:23], v250 offset:3072
    ds_read_b128 v[24:27], v250 offset:4096
    ds_read_b128 v[28:31], v250 offset:5120
    ds_read_b128 v[32:35], v250 offset:6144
    ds_read_b128 v[36:39], v250 offset:7168
    ds_read_b128 v[40:43], v250 offset:8192
    s_cmp_eq_u32 s61, 0
    s_cbranch_scc1 P2q_23
    v_mov_b32 v140, v241
    v_mov_b32 v141, v241
    v_mov_b32 v142, v241
    v_mov_b32 v143, v241
    v_mov_b32 v144, v241
    v_mov_b32 v145, v241
    v_mov_b32 v146, v241
    v_mov_b32 v147, v241
    v_mov_b32 v148, v241
    v_mov_b32 v149, v241
    v_mov_b32 v150, v241
    v_mov_b32 v151, v241
    v_mov_b32 v152, v241
    v_mov_b32 v153, v241
    v_mov_b32 v154, v241
    v_mov_b32 v155, v241
P2q_23:
    s_waitcnt vmcnt(0) lgkmcnt(0)
    s_add_u32 m0, s70, 0
    s_add_u32 s72, s71, 0
    buffer_load_dwordx4 v2, s[56:59], s72 offen lds
    s_add_u32 m0, s70, 1024
    s_add_u32 s72, s71, 0
    buffer_load_dwordx4 v3, s[56:59], s72 offen lds
    s_add_u32 m0, s70, 2048
    s_add_u32 s72, s71, 0
    buffer_load_dwordx4 v252, s[56:59], s72 offen lds
    s_mov_b32 s48, s20
    s_mov_b32 s49, s21
    s_mov_b32 s50, 0x80000
    s_mov_b32 s51, 0x20000
    s_lshl_b32 s74, s38, 16
    s_lshr_b32 s75, s40, 2
    s_lshl_b32 s75, s75, 7
    s_add_u32 s74, s74, s75
    s_lshl_b32 s75, s38, 13
    s_and_b32 s76, s40, 3
    s_lshl_b32 s76, s76, 11
    v_mov_b32 v245, v241
    v_mov_b32 v246, v241
    s_cmp_gt_u32 s61, 0
    s_cbranch_scc1 P2m_24
    v_mfma_f32_32x32x16_bf16 v[44:59], v[8:11], v[4:7], v[188:203]
P2m_24:
    s_cmp_gt_u32 s61, 1
    s_cbranch_scc1 P2m_25
    v_mfma_f32_32x32x16_bf16 v[60:75], v[12:15], v[4:7], 0
P2m_25:
    s_nop 5
    s_cmp_gt_u32 s61, 2
    s_cbranch_scc1 P2m_26
    v_mfma_f32_32x32x16_bf16 v[76:91], v[16:19], v[4:7], 0
P2m_26:
    v_max3_f32 v245, v44, v45, v245
    v_max3_f32 v246, v46, v47, v246
    v_max3_f32 v245, v48, v49, v245
    v_max3_f32 v246, v50, v51, v246
    v_max3_f32 v245, v52, v53, v245
    v_max3_f32 v246, v54, v55, v246
    v_max3_f32 v245, v56, v57, v245
    v_max3_f32 v246, v58, v59, v246
    s_cmp_gt_u32 s61, 3
    s_cbranch_scc1 P2m_27
    v_mfma_f32_32x32x16_bf16 v[92:107], v[20:23], v[4:7], 0
P2m_27:
    v_max3_f32 v245, v60, v61, v245
    v_max3_f32 v246, v62, v63, v246
    v_max3_f32 v245, v64, v65, v245
    v_max3_f32 v246, v66, v67, v246
    v_max3_f32 v245, v68, v69, v245
    v_max3_f32 v246, v70, v71, v246
    v_max3_f32 v245, v72, v73, v245
    v_max3_f32 v246, v74, v75, v246
    s_cmp_gt_u32 s61, 4
    s_cbranch_scc1 P2m_28
    v_mfma_f32_32x32x16_bf16 v[108:123], v[24:27], v[4:7], 0
P2m_28:
    v_max3_f32 v245, v76, v77, v245
    v_max3_f32 v246, v78, v79, v246
    v_max3_f32 v245, v80, v81, v245
    v_max3_f32 v246, v82, v83, v246
    v_max3_f32 v245, v84, v85, v245
    v_max3_f32 v246, v86, v87, v246
    v_max3_f32 v245, v88, v89, v245
    v_max3_f32 v246, v90, v91, v246
    s_cmp_gt_u32 s61, 5
    s_cbranch_scc1 P2m_29
    v_mfma_f32_32x32x16_bf16 v[124:139], v[28:31], v[4:7], 0
P2m_29:
    v_max3_f32 v245, v92, v93, v245
    v_max3_f32 v246, v94, v95, v246
    v_max3_f32 v245, v96, v97, v245
    v_max3_f32 v246, v98, v99, v246
    v_max3_f32 v245, v100, v101, v245
    v_max3_f32 v246, v102, v103, v246
    v_max3_f32 v245, v104, v105, v245
    v_max3_f32 v246, v106, v107, v246
    s_cmp_gt_u32 s61, 6
    s_cbranch_scc1 P2m_30
    v_mfma_f32_32x32x16_bf16 v[140:155], v[32:35], v[4:7], 0
P2m_30:
    v_max3_f32 v245, v108, v109, v245
    v_max3_f32 v246, v110, v111, v246
    v_max3_f32 v245, v112, v113, v245
    v_max3_f32 v246, v114, v115, v246
    v_max3_f32 v245, v116, v117, v245
    v_max3_f32 v246, v118, v119, v246
    v_max3_f32 v245, v120, v121, v245
    v_max3_f32 v246, v122, v123, v246
    s_cmp_gt_u32 s61, 7
    s_cbranch_scc1 P2m_31
    v_mfma_f32_32x32x16_bf16 v[156:171], v[36:39], v[4:7], 0
P2m_31:
    v_max3_f32 v245, v124, v125, v245
    v_max3_f32 v246, v126, v127, v246
    v_max3_f32 v245, v128, v129, v245
    v_max3_f32 v246, v130, v131, v246
    v_max3_f32 v245, v132, v133, v245
    v_max3_f32 v246, v134, v135, v246
    v_max3_f32 v245, v136, v137, v245
    v_max3_f32 v246, v138, v139, v246
    v_mfma_f32_32x32x16_bf16 v[172:187], v[40:43], v[4:7], v[204:219]
    v_max3_f32 v245, v140, v141, v245
    v_max3_f32 v246, v142, v143, v246
    v_max3_f32 v245, v144, v145, v245
    v_max3_f32 v246, v146, v147, v246
    v_max3_f32 v245, v148, v149, v245
    v_max3_f32 v246, v150, v151, v246
    v_max3_f32 v245, v152, v153, v245
    v_max3_f32 v246, v154, v155, v246
    s_nop 0
    v_max3_f32 v245, v156, v157, v245
    v_max3_f32 v246, v158, v159, v246
    v_max3_f32 v245, v160, v161, v245
    v_max3_f32 v246, v162, v163, v246
    v_max3_f32 v245, v164, v165, v245
    v_max3_f32 v246, v166, v167, v246
    v_max3_f32 v245, v168, v169, v245
    v_max3_f32 v246, v170, v171, v246
    s_nop 0
    v_max3_f32 v245, v172, v173, v245
    v_max3_f32 v246, v174, v175, v246
    v_max3_f32 v245, v176, v177, v245
    v_max3_f32 v246, v178, v179, v246
    v_max3_f32 v245, v180, v181, v245
    v_max3_f32 v246, v182, v183, v246
    v_max3_f32 v245, v184, v185, v245
    v_max3_f32 v246, v186, v187, v246
    v_max_f32 v245, v245, v246
    v_mov_b32 v246, v245
    s_nop 1
    v_permlane32_swap_b32 v245, v246
    s_nop 0
    v_max_f32 v245, v245, v246
    s_add_u32 m0, s70, 3072
    s_add_u32 s72, s71, 44032
    buffer_load_dwordx4 v2, s[56:59], s72 offen lds
    s_add_u32 m0, s70, 4096
    s_add_u32 s72, s71, 44032
    buffer_load_dwordx4 v3, s[56:59], s72 offen lds
    s_add_u32 m0, s70, 5120
    s_add_u32 s72, s71, 44032
    buffer_load_dwordx4 v252, s[56:59], s72 offen lds
    s_cmp_ge_u32 s38, 6
    s_cbranch_scc1 WU_33
    s_mov_b32 s44, s28
    s_mov_b32 s45, s29
    s_mov_b32 s46, 0x158000
    s_mov_b32 s47, 0x20000
    v_lshlrev_b32 v141, 7, v1
    s_mul_i32 s77, s40, 44032
    s_lshl_b32 s78, s38, 13
    s_add_u32 s77, s77, s78
    buffer_load_dword v140, v141, s[44:47], s77 offen
WU_33:
    v_sub_f32 v76, 0, v245
    v_sub_f32 v77, 0, v245
    v_sub_f32 v78, 0, v245
    v_sub_f32 v79, 0, v245
    v_sub_f32 v80, 0, v245
    v_sub_f32 v81, 0, v245
    v_sub_f32 v82, 0, v245
    v_sub_f32 v83, 0, v245
    v_sub_f32 v84, 0, v245
    v_sub_f32 v85, 0, v245
    v_sub_f32 v86, 0, v245
    v_sub_f32 v87, 0, v245
    v_sub_f32 v88, 0, v245
    v_sub_f32 v89, 0, v245
    v_sub_f32 v90, 0, v245
    v_sub_f32 v91, 0, v245
    v_sub_f32 v188, v188, v245
    v_sub_f32 v189, v189, v245
    v_sub_f32 v190, v190, v245
    v_sub_f32 v191, v191, v245
    v_sub_f32 v192, v192, v245
    v_sub_f32 v193, v193, v245
    v_sub_f32 v194, v194, v245
    v_sub_f32 v195, v195, v245
    v_sub_f32 v196, v196, v245
    v_sub_f32 v197, v197, v245
    v_sub_f32 v198, v198, v245
    v_sub_f32 v199, v199, v245
    v_sub_f32 v200, v200, v245
    v_sub_f32 v201, v201, v245
    v_sub_f32 v202, v202, v245
    v_sub_f32 v203, v203, v245
    v_sub_f32 v204, v204, v245
    v_sub_f32 v205, v205, v245
    v_sub_f32 v206, v206, v245
    v_sub_f32 v207, v207, v245
    v_sub_f32 v208, v208, v245
    v_sub_f32 v209, v209, v245
    v_sub_f32 v210, v210, v245
    v_sub_f32 v211, v211, v245
    v_sub_f32 v212, v212, v245
    v_sub_f32 v213, v213, v245
    v_sub_f32 v214, v214, v245
    v_sub_f32 v215, v215, v245
    v_sub_f32 v216, v216, v245
    v_sub_f32 v217, v217, v245
    v_sub_f32 v218, v218, v245
    v_sub_f32 v219, v219, v245
    s_cmp_eq_u32 s61, 0
    s_cbranch_scc1 P2r_34
    v_mov_b32 v44, v241
    v_mov_b32 v45, v241
    v_mov_b32 v46, v241
    v_mov_b32 v47, v241
    v_mov_b32 v48, v241
    v_mov_b32 v49, v241
    v_mov_b32 v50, v241
    v_mov_b32 v51, v241
    v_mov_b32 v52, v241
    v_mov_b32 v53, v241
    v_mov_b32 v54, v241
    v_mov_b32 v55, v241
    v_mov_b32 v56, v241
    v_mov_b32 v57, v241
    v_mov_b32 v58, v241
    v_mov_b32 v59, v241
    v_mov_b32 v60, v241
    v_mov_b32 v61, v241
    v_mov_b32 v62, v241
    v_mov_b32 v63, v241
    v_mov_b32 v64, v241
    v_mov_b32 v65, v241
    v_mov_b32 v66, v241
    v_mov_b32 v67, v241
    v_mov_b32 v68, v241
    v_mov_b32 v69, v241
    v_mov_b32 v70, v241
    v_mov_b32 v71, v241
    v_mov_b32 v72, v241
    v_mov_b32 v73, v241
    v_mov_b32 v74, v241
    v_mov_b32 v75, v241
P2r_34:
    ds_read_b128 v[108:111], v251 offset:0
    ds_read_b128 v[112:115], v251 offset:528
    s_cmp_gt_u32 s61, 0
    s_cbranch_scc1 P2n_35
    v_mfma_f32_32x32x16_bf16 v[44:59], v[8:11], v[4:7], v[188:203]
P2n_35:
    s_nop 9
    ds_read_b128 v[116:119], v251 offset:1056
    ds_read_b128 v[120:123], v251 offset:1584
    s_cmp_gt_u32 s61, 1
    s_cbranch_scc1 P2n_36
    v_mfma_f32_32x32x16_bf16 v[60:75], v[12:15], v[4:7], v[76:91]
P2n_36:
    v_exp_f32 v124, v44
    v_exp_f32 v125, v45
    v_exp_f32 v126, v46
    v_exp_f32 v127, v47
    v_exp_f32 v128, v48
    v_exp_f32 v129, v49
    v_exp_f32 v130, v50
    v_exp_f32 v131, v51
    v_exp_f32 v132, v52
    v_exp_f32 v133, v53
    v_exp_f32 v134, v54
    v_exp_f32 v135, v55
    v_exp_f32 v136, v56
    v_exp_f32 v137, v57
    v_exp_f32 v138, v58
    v_exp_f32 v139, v59
    v_cvt_pk_bf16_f32 v92, v124, v125
    v_cvt_pk_bf16_f32 v93, v126, v127
    v_cvt_pk_bf16_f32 v94, v128, v129
    v_cvt_pk_bf16_f32 v95, v130, v131
    v_cvt_pk_bf16_f32 v96, v132, v133
    v_cvt_pk_bf16_f32 v97, v134, v135
    v_cvt_pk_bf16_f32 v98, v136, v137
    v_cvt_pk_bf16_f32 v99, v138, v139
    s_waitcnt lgkmcnt(2)
    s_nop 0
    v_mfma_f32_32x32x16_bf16 v[220:235], v[108:111], v[92:95], 0
    v_mfma_f32_32x32x16_bf16 v[220:235], v[112:115], v[96:99], v[220:235]
    ds_read_b128 v[108:111], v251 offset:2112
    ds_read_b128 v[112:115], v251 offset:2640
    s_cmp_gt_u32 s61, 2
    s_cbranch_scc1 P2n_37
    v_mfma_f32_32x32x16_bf16 v[44:59], v[16:19], v[4:7], v[76:91]
P2n_37:
    v_exp_f32 v124, v60
    v_exp_f32 v125, v61
    v_exp_f32 v126, v62
    v_exp_f32 v127, v63
    v_exp_f32 v128, v64
    v_exp_f32 v129, v65
    v_exp_f32 v130, v66
    v_exp_f32 v131, v67
    v_exp_f32 v132, v68
    v_exp_f32 v133, v69
    v_exp_f32 v134, v70
    v_exp_f32 v135, v71
    v_exp_f32 v136, v72
    v_exp_f32 v137, v73
    v_exp_f32 v138, v74
    v_exp_f32 v139, v75
    v_cvt_pk_bf16_f32 v100, v124, v125
    v_cvt_pk_bf16_f32 v101, v126, v127
    v_cvt_pk_bf16_f32 v102, v128, v129
    v_cvt_pk_bf16_f32 v103, v130, v131
    v_cvt_pk_bf16_f32 v104, v132, v133
    v_cvt_pk_bf16_f32 v105, v134, v135
    v_cvt_pk_bf16_f32 v106, v136, v137
    v_cvt_pk_bf16_f32 v107, v138, v139
    s_waitcnt lgkmcnt(2)
    s_nop 0
    v_mfma_f32_32x32x16_bf16 v[220:235], v[116:119], v[100:103], v[220:235]
    v_mfma_f32_32x32x16_bf16 v[220:235], v[120:123], v[104:107], v[220:235]
    ds_read_b128 v[116:119], v251 offset:3168
    ds_read_b128 v[120:123], v251 offset:3696
    s_cmp_gt_u32 s61, 3
    s_cbranch_scc1 P2n_38
    v_mfma_f32_32x32x16_bf16 v[60:75], v[20:23], v[4:7], v[76:91]
P2n_38:
    v_exp_f32 v124, v44
    v_exp_f32 v125, v45
    v_exp_f32 v126, v46
    v_exp_f32 v127, v47
    v_exp_f32 v128, v48
    v_exp_f32 v129, v49
    v_exp_f32 v130, v50
    v_exp_f32 v131, v51
    v_exp_f32 v132, v52
    v_exp_f32 v133, v53
    v_exp_f32 v134, v54
    v_exp_f32 v135, v55
    v_exp_f32 v136, v56
    v_exp_f32 v137, v57
    v_exp_f32 v138, v58
    v_exp_f32 v139, v59
    v_cvt_pk_bf16_f32 v92, v124, v125
    v_cvt_pk_bf16_f32 v93, v126, v127
    v_cvt_pk_bf16_f32 v94, v128, v129
    v_cvt_pk_bf16_f32 v95, v130, v131
    v_cvt_pk_bf16_f32 v96, v132, v133
    v_cvt_pk_bf16_f32 v97, v134, v135
    v_cvt_pk_bf16_f32 v98, v136, v137
    v_cvt_pk_bf16_f32 v99, v138, v139
    s_waitcnt lgkmcnt(2)
    s_nop 0
    v_mfma_f32_32x32x16_bf16 v[220:235], v[108:111], v[92:95], v[220:235]
    v_mfma_f32_32x32x16_bf16 v[220:235], v[112:115], v[96:99], v[220:235]
    ds_read_b128 v[108:111], v251 offset:4224
    ds_read_b128 v[112:115], v251 offset:4752
    s_cmp_gt_u32 s61, 4
    s_cbranch_scc1 P2n_39
    v_mfma_f32_32x32x16_bf16 v[44:59], v[24:27], v[4:7], v[76:91]
P2n_39:
    v_exp_f32 v124, v60
    v_exp_f32 v125, v61
    v_exp_f32 v126, v62
    v_exp_f32 v127, v63
    v_exp_f32 v128, v64
    v_exp_f32 v129, v65
    v_exp_f32 v130, v66
    v_exp_f32 v131, v67
    v_exp_f32 v132, v68
    v_exp_f32 v133, v69
    v_exp_f32 v134, v70
    v_exp_f32 v135, v71
    v_exp_f32 v136, v72
    v_exp_f32 v137, v73
    v_exp_f32 v138, v74
    v_exp_f32 v139, v75
    v_cvt_pk_bf16_f32 v100, v124, v125
    v_cvt_pk_bf16_f32 v101, v126, v127
    v_cvt_pk_bf16_f32 v102, v128, v129
    v_cvt_pk_bf16_f32 v103, v130, v131
    v_cvt_pk_bf16_f32 v104, v132, v133
    v_cvt_pk_bf16_f32 v105, v134, v135
    v_cvt_pk_bf16_f32 v106, v136, v137
    v_cvt_pk_bf16_f32 v107, v138, v139
    s_waitcnt lgkmcnt(2)
    s_nop 0
    v_mfma_f32_32x32x16_bf16 v[220:235], v[116:119], v[100:103], v[220:235]
    v_mfma_f32_32x32x16_bf16 v[220:235], v[120:123], v[104:107], v[220:235]
    ds_read_b128 v[116:119], v251 offset:5280
    ds_read_b128 v[120:123], v251 offset:5808
    s_cmp_gt_u32 s61, 5
    s_cbranch_scc1 P2n_40
    v_mfma_f32_32x32x16_bf16 v[60:75], v[28:31], v[4:7], v[76:91]
P2n_40:
    v_exp_f32 v124, v44
    v_exp_f32 v125, v45
    v_exp_f32 v126, v46
    v_exp_f32 v127, v47
    v_exp_f32 v128, v48
    v_exp_f32 v129, v49
    v_exp_f32 v130, v50
    v_exp_f32 v131, v51
    v_exp_f32 v132, v52
    v_exp_f32 v133, v53
    v_exp_f32 v134, v54
    v_exp_f32 v135, v55
    v_exp_f32 v136, v56
    v_exp_f32 v137, v57
    v_exp_f32 v138, v58
    v_exp_f32 v139, v59
    v_cvt_pk_bf16_f32 v92, v124, v125
    v_cvt_pk_bf16_f32 v93, v126, v127
    v_cvt_pk_bf16_f32 v94, v128, v129
    v_cvt_pk_bf16_f32 v95, v130, v131
    v_cvt_pk_bf16_f32 v96, v132, v133
    v_cvt_pk_bf16_f32 v97, v134, v135
    v_cvt_pk_bf16_f32 v98, v136, v137
    v_cvt_pk_bf16_f32 v99, v138, v139
    s_waitcnt lgkmcnt(2)
    s_nop 0
    v_mfma_f32_32x32x16_bf16 v[220:235], v[108:111], v[92:95], v[220:235]
    v_mfma_f32_32x32x16_bf16 v[220:235], v[112:115], v[96:99], v[220:235]
    ds_read_b128 v[108:111], v251 offset:6336
    ds_read_b128 v[112:115], v251 offset:6864
    s_cmp_gt_u32 s61, 6
    s_cbranch_scc1 P2n_41
    v_mfma_f32_32x32x16_bf16 v[44:59], v[32:35], v[4:7], v[76:91]
P2n_41:
    v_exp_f32 v124, v60
    v_exp_f32 v125, v61
    v_exp_f32 v126, v62
    v_exp_f32 v127, v63
    v_exp_f32 v128, v64
    v_exp_f32 v129, v65
    v_exp_f32 v130, v66
    v_exp_f32 v131, v67
    v_exp_f32 v132, v68
    v_exp_f32 v133, v69
    v_exp_f32 v134, v70
    v_exp_f32 v135, v71
    v_exp_f32 v136, v72
    v_exp_f32 v137, v73
    v_exp_f32 v138, v74
    v_exp_f32 v139, v75
    v_cvt_pk_bf16_f32 v100, v124, v125
    v_cvt_pk_bf16_f32 v101, v126, v127
    v_cvt_pk_bf16_f32 v102, v128, v129
    v_cvt_pk_bf16_f32 v103, v130, v131
    v_cvt_pk_bf16_f32 v104, v132, v133
    v_cvt_pk_bf16_f32 v105, v134, v135
    v_cvt_pk_bf16_f32 v106, v136, v137
    v_cvt_pk_bf16_f32 v107, v138, v139
    s_waitcnt lgkmcnt(2)
    s_nop 0
    v_mfma_f32_32x32x16_bf16 v[220:235], v[116:119], v[100:103], v[220:235]
    v_mfma_f32_32x32x16_bf16 v[220:235], v[120:123], v[104:107], v[220:235]
    ds_read_b128 v[116:119], v251 offset:7392
    ds_read_b128 v[120:123], v251 offset:7920
    s_cmp_gt_u32 s61, 7
    s_cbranch_scc1 P2n_42
    v_mfma_f32_32x32x16_bf16 v[60:75], v[36:39], v[4:7], v[76:91]
P2n_42:
    v_exp_f32 v124, v44
    v_exp_f32 v125, v45
    v_exp_f32 v126, v46
    v_exp_f32 v127, v47
    v_exp_f32 v128, v48
    v_exp_f32 v129, v49
    v_exp_f32 v130, v50
    v_exp_f32 v131, v51
    v_exp_f32 v132, v52
    v_exp_f32 v133, v53
    v_exp_f32 v134, v54
    v_exp_f32 v135, v55
    v_exp_f32 v136, v56
    v_exp_f32 v137, v57
    v_exp_f32 v138, v58
    v_exp_f32 v139, v59
    v_cvt_pk_bf16_f32 v92, v124, v125
    v_cvt_pk_bf16_f32 v93, v126, v127
    v_cvt_pk_bf16_f32 v94, v128, v129
    v_cvt_pk_bf16_f32 v95, v130, v131
    v_cvt_pk_bf16_f32 v96, v132, v133
    v_cvt_pk_bf16_f32 v97, v134, v135
    v_cvt_pk_bf16_f32 v98, v136, v137
    v_cvt_pk_bf16_f32 v99, v138, v139
    s_waitcnt lgkmcnt(2)
    s_nop 0
    v_mfma_f32_32x32x16_bf16 v[220:235], v[108:111], v[92:95], v[220:235]
    v_mfma_f32_32x32x16_bf16 v[220:235], v[112:115], v[96:99], v[220:235]
    ds_read_b128 v[108:111], v251 offset:8448
    ds_read_b128 v[112:115], v251 offset:8976
    v_mfma_f32_32x32x16_bf16 v[44:59], v[40:43], v[4:7], v[204:219]
    v_exp_f32 v124, v60
    v_exp_f32 v125, v61
    v_exp_f32 v126, v62
    v_exp_f32 v127, v63
    v_exp_f32 v128, v64
    v_exp_f32 v129, v65
    v_exp_f32 v130, v66
    v_exp_f32 v131, v67
    v_exp_f32 v132, v68
    v_exp_f32 v133, v69
    v_exp_f32 v134, v70
    v_exp_f32 v135, v71
    v_exp_f32 v136, v72
    v_exp_f32 v137, v73
    v_exp_f32 v138, v74
    v_exp_f32 v139, v75
    v_cvt_pk_bf16_f32 v100, v124, v125
    v_cvt_pk_bf16_f32 v101, v126, v127
    v_cvt_pk_bf16_f32 v102, v128, v129
    v_cvt_pk_bf16_f32 v103, v130, v131
    v_cvt_pk_bf16_f32 v104, v132, v133
    v_cvt_pk_bf16_f32 v105, v134, v135
    v_cvt_pk_bf16_f32 v106, v136, v137
    v_cvt_pk_bf16_f32 v107, v138, v139
    s_waitcnt lgkmcnt(2)
    s_nop 0
    v_mfma_f32_32x32x16_bf16 v[220:235], v[116:119], v[100:103], v[220:235]
    v_mfma_f32_32x32x16_bf16 v[220:235], v[120:123], v[104:107], v[220:235]
    v_exp_f32 v124, v44
    v_exp_f32 v125, v45
    v_exp_f32 v126, v46
    v_exp_f32 v127, v47
    v_exp_f32 v128, v48
    v_exp_f32 v129, v49
    v_exp_f32 v130, v50
    v_exp_f32 v131, v51
    v_exp_f32 v132, v52
    v_exp_f32 v133, v53
    v_exp_f32 v134, v54
    v_exp_f32 v135, v55
    v_exp_f32 v136, v56
    v_exp_f32 v137, v57
    v_exp_f32 v138, v58
    v_exp_f32 v139, v59
    v_cvt_pk_bf16_f32 v92, v124, v125
    v_cvt_pk_bf16_f32 v93, v126, v127
    v_cvt_pk_bf16_f32 v94, v128, v129
    v_cvt_pk_bf16_f32 v95, v130, v131
    v_cvt_pk_bf16_f32 v96, v132, v133
    v_cvt_pk_bf16_f32 v97, v134, v135
    v_cvt_pk_bf16_f32 v98, v136, v137
    v_cvt_pk_bf16_f32 v99, v138, v139
    s_waitcnt lgkmcnt(0)
    s_nop 0
    v_mfma_f32_32x32x16_bf16 v[220:235], v[108:111], v[92:95], v[220:235]
    v_mfma_f32_32x32x16_bf16 v[220:235], v[112:115], v[96:99], v[220:235]
    s_nop 11
    v_rcp_f32 v245, v228
    s_nop 0
    v_mul_f32 v220, v220, v245
    v_mul_f32 v221, v221, v245
    v_mul_f32 v222, v222, v245
    v_mul_f32 v223, v223, v245
    v_mul_f32 v224, v224, v245
    v_mul_f32 v225, v225, v245
    v_mul_f32 v226, v226, v245
    v_mul_f32 v227, v227, v245
    v_cvt_pk_bf16_f32 v92, v220, v221
    v_cvt_pk_bf16_f32 v93, v222, v223
    v_cvt_pk_bf16_f32 v94, v224, v225
    v_cvt_pk_bf16_f32 v95, v226, v227
    s_lshl_b32 s64, s60, 15
    s_lshl_b32 s65, s62, 10
    s_add_u32 s64, s64, s65
    s_add_u32 s64, s64, 0x600000
    buffer_store_dwordx4 v[92:95], v236, s[52:55], s64 offen sc1
    v_and_b32 v249, 31, v1
    v_lshlrev_b32 v249, 10, v249
    s_lshl_b32 s66, s39, 7
    s_lshl_b32 s65, s40, 2
    s_add_u32 s66, s66, s65
    v_add_u32 v249, s66, v249
    s_waitcnt vmcnt(0)
    s_barrier
    s_cmp_lg_u32 s38, 0
    s_cbranch_scc1 PUB_44
    s_mov_b32 s92, 0x1208000
    v_mov_b32 v250, s42
    buffer_store_dword v250, v249, s[52:55], s92 offen sc1
PUB_44:
    s_and_b32 s60, s40, 3
    s_lshl_b32 s62, s39, 2
    s_add_u32 s60, s60, s62
    s_lshr_b32 s61, s40, 2
    s_cmp_ge_u32 s38, 4
    s_cbranch_scc1 P3H_45
    s_and_b32 s62, s38, 1
    s_lshr_b32 s63, s38, 1
    s_lshl_b32 s64, s60, 1
    s_add_u32 s64, s64, s62
    s_mov_b32 s56, s16
    s_mov_b32 s57, s17
    s_mov_b32 s58, 0x200000
    s_mov_b32 s59, 0x20000
    v_and_b32 v128, 31, v1
    v_lshrrev_b32 v129, 5, v1
    v_lshlrev_b32 v130, 10, v128
    v_lshl_add_u32 v130, v129, 3, v130
    s_lshl_b32 s65, s64, 15
    s_lshl_b32 s66, s61, 7
    s_add_u32 s65, s65, s66
    s_lshl_b32 s66, s63, 6
    s_add_u32 s65, s65, s66
    buffer_load_dwordx2 v[120:121], v130, s[56:59], s65 offen offset:0
    buffer_load_dwordx2 v[122:123], v130, s[56:59], s65 offen offset:16
    buffer_load_dwordx2 v[124:125], v130, s[56:59], s65 offen offset:32
    buffer_load_dwordx2 v[126:127], v130, s[56:59], s65 offen offset:48
    v_lshlrev_b32 v131, 4, v1
    s_lshl_b32 s65, s64, 15
    s_lshl_b32 s66, s63, 14
    s_add_u32 s65, s65, s66
    s_add_u32 s65, s65, 0x600000
    v_and_b32 v132, 15, v1
    v_lshrrev_b32 v133, 5, v1
    v_lshrrev_b32 v134, 2, v132
    v_lshl_add_u32 v134, v133, 2, v134
    v_lshlrev_b32 v134, 7, v134
    v_lshrrev_b32 v135, 3, v132
    v_lshl_add_u32 v134, v135, 6, v134
    v_bfe_u32 v135, v1, 4, 1
    v_lshl_add_u32 v134, v135, 5, v134
    v_and_b32 v135, 3, v132
    v_lshl_add_u32 v116, v135, 3, v134
    v_xor_b32 v117, 64, v116
    s_lshl_b32 s66, s63, 15
    s_add_u32 s66, s66, 0
    v_add_u32 v116, s66, v116
    v_add_u32 v117, s66, v117
    v_mov_b32 v2, 0
    v_mov_b32 v3, 0
    v_mov_b32 v4, 0
    v_mov_b32 v5, 0
    v_mov_b32 v6, 0
    v_mov_b32 v7, 0
    v_mov_b32 v8, 0
    v_mov_b32 v9, 0
    v_mov_b32 v10, 0
    v_mov_b32 v11, 0
    v_mov_b32 v12, 0
    v_mov_b32 v13, 0
    v_mov_b32 v14, 0
    v_mov_b32 v15, 0
    v_mov_b32 v16, 0
    v_mov_b32 v17, 0
    v_mov_b32 v18, 0
    v_mov_b32 v19, 0
    v_mov_b32 v20, 0
    v_mov_b32 v21, 0
    v_mov_b32 v22, 0
    v_mov_b32 v23, 0
    v_mov_b32 v24, 0
    v_mov_b32 v25, 0
    v_mov_b32 v26, 0
    v_mov_b32 v27, 0
    v_mov_b32 v28, 0
    v_mov_b32 v29, 0
    v_mov_b32 v30, 0
    v_mov_b32 v31, 0
    v_mov_b32 v32, 0
    v_mov_b32 v33, 0
    v_and_b32 v132, 31, v1
    v_lshlrev_b32 v132, 2, v132
    s_lshl_b32 s66, s2, 7
    v_add_u32 v132, s66, v132
    s_cmp_lg_u32 s38, 0
    s_cbranch_scc1 POD_48
    s_mov_b32 s92, 0x1208000
    s_mov_b32 s43, 300000
POL_47:
    buffer_load_dword v133, v132, s[52:55], s92 offen sc1
    s_waitcnt vmcnt(0)
    v_cmp_ne_u32 vcc, s42, v133
    s_cbranch_vccz POD_48
    s_sub_u32 s43, s43, 1
    s_cbranch_scc0 POL_47
POD_48:
    s_barrier
    buffer_load_dwordx4 v[36:39], v131, s[52:55], s65 offen offset:0 sc1
    buffer_load_dwordx4 v[40:43], v131, s[52:55], s65 offen offset:1024 sc1
    buffer_load_dwordx4 v[44:47], v131, s[52:55], s65 offen offset:2048 sc1
    buffer_load_dwordx4 v[48:51], v131, s[52:55], s65 offen offset:3072 sc1
    s_add_u32 s65, s65, 4096
    buffer_load_dwordx4 v[52:55], v131, s[52:55], s65 offen offset:0 sc1
    buffer_load_dwordx4 v[56:59], v131, s[52:55], s65 offen offset:1024 sc1
    buffer_load_dwordx4 v[60:63], v131, s[52:55], s65 offen offset:2048 sc1
    buffer_load_dwordx4 v[64:67], v131, s[52:55], s65 offen offset:3072 sc1
    s_add_u32 s65, s65, 4096
    buffer_load_dwordx4 v[68:71], v131, s[52:55], s65 offen offset:0 sc1
    buffer_load_dwordx4 v[72:75], v131, s[52:55], s65 offen offset:1024 sc1
    buffer_load_dwordx4 v[76:79], v131, s[52:55], s65 offen offset:2048 sc1
    buffer_load_dwordx4 v[80:83], v131, s[52:55], s65 offen offset:3072 sc1
    s_add_u32 s65, s65, 4096
    buffer_load_dwordx4 v[84:87], v131, s[52:55], s65 offen offset:0 sc1
    buffer_load_dwordx4 v[88:91], v131, s[52:55], s65 offen offset:1024 sc1
    buffer_load_dwordx4 v[92:95], v131, s[52:55], s65 offen offset:2048 sc1
    buffer_load_dwordx4 v[96:99], v131, s[52:55], s65 offen offset:3072 sc1
    ds_read_b64_tr_b16 v[100:101], v116 offset:0
    ds_read_b64_tr_b16 v[102:103], v116 offset:1024
    ds_read_b64_tr_b16 v[104:105], v117 offset:0
    ds_read_b64_tr_b16 v[106:107], v117 offset:1024
    ds_read_b64_tr_b16 v[108:109], v116 offset:2048
    ds_read_b64_tr_b16 v[110:111], v116 offset:3072
    ds_read_b64_tr_b16 v[112:113], v117 offset:2048
    ds_read_b64_tr_b16 v[114:115], v117 offset:3072
    s_waitcnt vmcnt(15) lgkmcnt(4)
    v_mfma_f32_32x32x16_bf16 v[2:17], v[100:103], v[36:39], v[2:17]
    v_mfma_f32_32x32x16_bf16 v[18:33], v[104:107], v[36:39], v[18:33]
    ds_read_b64_tr_b16 v[100:101], v116 offset:4096
    ds_read_b64_tr_b16 v[102:103], v116 offset:5120
    ds_read_b64_tr_b16 v[104:105], v117 offset:4096
    ds_read_b64_tr_b16 v[106:107], v117 offset:5120
    s_waitcnt vmcnt(14) lgkmcnt(4)
    v_mfma_f32_32x32x16_bf16 v[2:17], v[108:111], v[40:43], v[2:17]
    v_mfma_f32_32x32x16_bf16 v[18:33], v[112:115], v[40:43], v[18:33]
    ds_read_b64_tr_b16 v[108:109], v116 offset:6144
    ds_read_b64_tr_b16 v[110:111], v116 offset:7168
    ds_read_b64_tr_b16 v[112:113], v117 offset:6144
    ds_read_b64_tr_b16 v[114:115], v117 offset:7168
    s_waitcnt vmcnt(13) lgkmcnt(4)
    v_mfma_f32_32x32x16_bf16 v[2:17], v[100:103], v[44:47], v[2:17]
    v_mfma_f32_32x32x16_bf16 v[18:33], v[104:107], v[44:47], v[18:33]
    ds_read_b64_tr_b16 v[100:101], v116 offset:8192
    ds_read_b64_tr_b16 v[102:103], v116 offset:9216
    ds_read_b64_tr_b16 v[104:105], v117 offset:8192
    ds_read_b64_tr_b16 v[106:107], v117 offset:9216
    s_waitcnt vmcnt(12) lgkmcnt(4)
    v_mfma_f32_32x32x16_bf16 v[2:17], v[108:111], v[48:51], v[2:17]
    v_mfma_f32_32x32x16_bf16 v[18:33], v[112:115], v[48:51], v[18:33]
    ds_read_b64_tr_b16 v[108:109], v116 offset:10240
    ds_read_b64_tr_b16 v[110:111], v116 offset:11264
    ds_read_b64_tr_b16 v[112:113], v117 offset:10240
    ds_read_b64_tr_b16 v[114:115], v117 offset:11264
    s_waitcnt vmcnt(11) lgkmcnt(4)
    v_mfma_f32_32x32x16_bf16 v[2:17], v[100:103], v[52:55], v[2:17]
    v_mfma_f32_32x32x16_bf16 v[18:33], v[104:107], v[52:55], v[18:33]
    ds_read_b64_tr_b16 v[100:101], v116 offset:12288
    ds_read_b64_tr_b16 v[102:103], v116 offset:13312
    ds_read_b64_tr_b16 v[104:105], v117 offset:12288
    ds_read_b64_tr_b16 v[106:107], v117 offset:13312
    s_waitcnt vmcnt(10) lgkmcnt(4)
    v_mfma_f32_32x32x16_bf16 v[2:17], v[108:111], v[56:59], v[2:17]
    v_mfma_f32_32x32x16_bf16 v[18:33], v[112:115], v[56:59], v[18:33]
    ds_read_b64_tr_b16 v[108:109], v116 offset:14336
    ds_read_b64_tr_b16 v[110:111], v116 offset:15360
    ds_read_b64_tr_b16 v[112:113], v117 offset:14336
    ds_read_b64_tr_b16 v[114:115], v117 offset:15360
    s_waitcnt vmcnt(9) lgkmcnt(4)
    v_mfma_f32_32x32x16_bf16 v[2:17], v[100:103], v[60:63], v[2:17]
    v_mfma_f32_32x32x16_bf16 v[18:33], v[104:107], v[60:63], v[18:33]
    ds_read_b64_tr_b16 v[100:101], v116 offset:16384
    ds_read_b64_tr_b16 v[102:103], v116 offset:17408
    ds_read_b64_tr_b16 v[104:105], v117 offset:16384
    ds_read_b64_tr_b16 v[106:107], v117 offset:17408
    s_waitcnt vmcnt(8) lgkmcnt(4)
    v_mfma_f32_32x32x16_bf16 v[2:17], v[108:111], v[64:67], v[2:17]
    v_mfma_f32_32x32x16_bf16 v[18:33], v[112:115], v[64:67], v[18:33]
    ds_read_b64_tr_b16 v[108:109], v116 offset:18432
    ds_read_b64_tr_b16 v[110:111], v116 offset:19456
    ds_read_b64_tr_b16 v[112:113], v117 offset:18432
    ds_read_b64_tr_b16 v[114:115], v117 offset:19456
    s_waitcnt vmcnt(7) lgkmcnt(4)
    v_mfma_f32_32x32x16_bf16 v[2:17], v[100:103], v[68:71], v[2:17]
    v_mfma_f32_32x32x16_bf16 v[18:33], v[104:107], v[68:71], v[18:33]
    ds_read_b64_tr_b16 v[100:101], v116 offset:20480
    ds_read_b64_tr_b16 v[102:103], v116 offset:21504
    ds_read_b64_tr_b16 v[104:105], v117 offset:20480
    ds_read_b64_tr_b16 v[106:107], v117 offset:21504
    s_waitcnt vmcnt(6) lgkmcnt(4)
    v_mfma_f32_32x32x16_bf16 v[2:17], v[108:111], v[72:75], v[2:17]
    v_mfma_f32_32x32x16_bf16 v[18:33], v[112:115], v[72:75], v[18:33]
    ds_read_b64_tr_b16 v[108:109], v116 offset:22528
    ds_read_b64_tr_b16 v[110:111], v116 offset:23552
    ds_read_b64_tr_b16 v[112:113], v117 offset:22528
    ds_read_b64_tr_b16 v[114:115], v117 offset:23552
    s_waitcnt vmcnt(5) lgkmcnt(4)
    v_mfma_f32_32x32x16_bf16 v[2:17], v[100:103], v[76:79], v[2:17]
    v_mfma_f32_32x32x16_bf16 v[18:33], v[104:107], v[76:79], v[18:33]
    ds_read_b64_tr_b16 v[100:101], v116 offset:24576
    ds_read_b64_tr_b16 v[102:103], v116 offset:25600
    ds_read_b64_tr_b16 v[104:105], v117 offset:24576
    ds_read_b64_tr_b16 v[106:107], v117 offset:25600
    s_waitcnt vmcnt(4) lgkmcnt(4)
    v_mfma_f32_32x32x16_bf16 v[2:17], v[108:111], v[80:83], v[2:17]
    v_mfma_f32_32x32x16_bf16 v[18:33], v[112:115], v[80:83], v[18:33]
    ds_read_b64_tr_b16 v[108:109], v116 offset:26624
    ds_read_b64_tr_b16 v[110:111], v116 offset:27648
    ds_read_b64_tr_b16 v[112:113], v117 offset:26624
    ds_read_b64_tr_b16 v[114:115], v117 offset:27648
    s_waitcnt vmcnt(3) lgkmcnt(4)
    v_mfma_f32_32x32x16_bf16 v[2:17], v[100:103], v[84:87], v[2:17]
    v_mfma_f32_32x32x16_bf16 v[18:33], v[104:107], v[84:87], v[18:33]
    ds_read_b64_tr_b16 v[100:101], v116 offset:28672
    ds_read_b64_tr_b16 v[102:103], v116 offset:29696
    ds_read_b64_tr_b16 v[104:105], v117 offset:28672
    ds_read_b64_tr_b16 v[106:107], v117 offset:29696
    s_waitcnt vmcnt(2) lgkmcnt(4)
    v_mfma_f32_32x32x16_bf16 v[2:17], v[108:111], v[88:91], v[2:17]
    v_mfma_f32_32x32x16_bf16 v[18:33], v[112:115], v[88:91], v[18:33]
    ds_read_b64_tr_b16 v[108:109], v116 offset:30720
    ds_read_b64_tr_b16 v[110:111], v116 offset:31744
    ds_read_b64_tr_b16 v[112:113], v117 offset:30720
    ds_read_b64_tr_b16 v[114:115], v117 offset:31744
    s_waitcnt vmcnt(1) lgkmcnt(4)
    v_mfma_f32_32x32x16_bf16 v[2:17], v[100:103], v[92:95], v[2:17]
    v_mfma_f32_32x32x16_bf16 v[18:33], v[104:107], v[92:95], v[18:33]
    s_waitcnt vmcnt(0) lgkmcnt(0)
    v_mfma_f32_32x32x16_bf16 v[2:17], v[108:111], v[96:99], v[2:17]
    v_mfma_f32_32x32x16_bf16 v[18:33], v[112:115], v[96:99], v[18:33]
    s_barrier
    s_nop 11
    s_cmp_eq_u32 s63, 0
    s_cbranch_scc1 P3k_49
    v_mov_b32 v144, v2
    v_mov_b32 v2, v18
    v_mov_b32 v18, v144
    v_mov_b32 v145, v3
    v_mov_b32 v3, v19
    v_mov_b32 v19, v145
    v_mov_b32 v146, v4
    v_mov_b32 v4, v20
    v_mov_b32 v20, v146
    v_mov_b32 v147, v5
    v_mov_b32 v5, v21
    v_mov_b32 v21, v147
    v_mov_b32 v148, v6
    v_mov_b32 v6, v22
    v_mov_b32 v22, v148
    v_mov_b32 v149, v7
    v_mov_b32 v7, v23
    v_mov_b32 v23, v149
    v_mov_b32 v150, v8
    v_mov_b32 v8, v24
    v_mov_b32 v24, v150
    v_mov_b32 v151, v9
    v_mov_b32 v9, v25
    v_mov_b32 v25, v151
    v_mov_b32 v152, v10
    v_mov_b32 v10, v26
    v_mov_b32 v26, v152
    v_mov_b32 v153, v11
    v_mov_b32 v11, v27
    v_mov_b32 v27, v153
    v_mov_b32 v154, v12
    v_mov_b32 v12, v28
    v_mov_b32 v28, v154
    v_mov_b32 v155, v13
    v_mov_b32 v13, v29
    v_mov_b32 v29, v155
    v_mov_b32 v156, v14
    v_mov_b32 v14, v30
    v_mov_b32 v30, v156
    v_mov_b32 v157, v15
    v_mov_b32 v15, v31
    v_mov_b32 v31, v157
    v_mov_b32 v158, v16
    v_mov_b32 v16, v32
    v_mov_b32 v32, v158
    v_mov_b32 v159, v17
    v_mov_b32 v17, v33
    v_mov_b32 v33, v159
P3k_49:
    s_lshl_b32 s70, s38, 12
    s_add_u32 s70, s70, 0
    v_lshlrev_b32 v132, 4, v1
    v_add_u32 v133, s70, v132
    s_xor_b32 s71, s38, 2
    s_lshl_b32 s71, s71, 12
    s_add_u32 s71, s71, 0
    v_add_u32 v134, s71, v132
    ds_write_b128 v133, v[18:21] offset:0
    ds_write_b128 v133, v[22:25] offset:1024
    ds_write_b128 v133, v[26:29] offset:2048
    ds_write_b128 v133, v[30:33] offset:3072
    s_waitcnt lgkmcnt(0)
    s_barrier
    ds_read_b128 v[144:147], v134 offset:0
    ds_read_b128 v[148:151], v134 offset:1024
    ds_read_b128 v[152:155], v134 offset:2048
    ds_read_b128 v[156:159], v134 offset:3072
    s_waitcnt lgkmcnt(0)
    v_add_f32 v2, v2, v144
    v_add_f32 v3, v3, v145
    v_add_f32 v4, v4, v146
    v_add_f32 v5, v5, v147
    v_add_f32 v6, v6, v148
    v_add_f32 v7, v7, v149
    v_add_f32 v8, v8, v150
    v_add_f32 v9, v9, v151
    v_add_f32 v10, v10, v152
    v_add_f32 v11, v11, v153
    v_add_f32 v12, v12, v154
    v_add_f32 v13, v13, v155
    v_add_f32 v14, v14, v156
    v_add_f32 v15, v15, v157
    v_add_f32 v16, v16, v158
    v_add_f32 v17, v17, v159
    v_lshlrev_b32 v136, 16, v120
    v_and_b32 v137, 0xffff0000, v120
    v_add_f32 v2, v2, v136
    v_add_f32 v3, v3, v137
    v_lshlrev_b32 v136, 16, v121
    v_and_b32 v137, 0xffff0000, v121
    v_add_f32 v4, v4, v136
    v_add_f32 v5, v5, v137
    v_lshlrev_b32 v136, 16, v122
    v_and_b32 v137, 0xffff0000, v122
    v_add_f32 v6, v6, v136
    v_add_f32 v7, v7, v137
    v_lshlrev_b32 v136, 16, v123
    v_and_b32 v137, 0xffff0000, v123
    v_add_f32 v8, v8, v136
    v_add_f32 v9, v9, v137
    v_lshlrev_b32 v136, 16, v124
    v_and_b32 v137, 0xffff0000, v124
    v_add_f32 v10, v10, v136
    v_add_f32 v11, v11, v137
    v_lshlrev_b32 v136, 16, v125
    v_and_b32 v137, 0xffff0000, v125
    v_add_f32 v12, v12, v136
    v_add_f32 v13, v13, v137
    v_lshlrev_b32 v136, 16, v126
    v_and_b32 v137, 0xffff0000, v126
    v_add_f32 v14, v14, v136
    v_add_f32 v15, v15, v137
    v_lshlrev_b32 v136, 16, v127
    v_and_b32 v137, 0xffff0000, v127
    v_add_f32 v16, v16, v136
    v_add_f32 v17, v17, v137
    v_cvt_pk_bf16_f32 v240, v2, v3
    v_cvt_pk_bf16_f32 v241, v4, v5
    v_cvt_pk_bf16_f32 v242, v6, v7
    v_cvt_pk_bf16_f32 v243, v8, v9
    v_cvt_pk_bf16_f32 v244, v10, v11
    v_cvt_pk_bf16_f32 v245, v12, v13
    v_cvt_pk_bf16_f32 v246, v14, v15
    v_cvt_pk_bf16_f32 v247, v16, v17
    s_lshl_b32 s65, s64, 15
    s_lshl_b32 s66, s61, 12
    s_add_u32 s65, s65, s66
    s_lshl_b32 s66, s63, 11
    s_add_u32 s65, s65, s66
    s_add_u32 s65, s65, 0x800000
    s_mov_b32 s67, s65
    buffer_store_dwordx4 v[240:243], v131, s[52:55], s65 offen sc1
    buffer_store_dwordx4 v[244:247], v131, s[52:55], s65 offen offset:1024 sc1
    v_mov_b32 v136, 0
    v_mov_b32 v137, 0
    v_mov_b32 v138, 0x3f803f80
    v_dot2c_f32_bf16 v136, v138, v240
    v_dot2c_f32_bf16 v137, v240, v240
    v_dot2c_f32_bf16 v136, v138, v241
    v_dot2c_f32_bf16 v137, v241, v241
    v_dot2c_f32_bf16 v136, v138, v242
    v_dot2c_f32_bf16 v137, v242, v242
    v_dot2c_f32_bf16 v136, v138, v243
    v_dot2c_f32_bf16 v137, v243, v243
    v_dot2c_f32_bf16 v136, v138, v244
    v_dot2c_f32_bf16 v137, v244, v244
    v_dot2c_f32_bf16 v136, v138, v245
    v_dot2c_f32_bf16 v137, v245, v245
    v_dot2c_f32_bf16 v136, v138, v246
    v_dot2c_f32_bf16 v137, v246, v246
    v_dot2c_f32_bf16 v136, v138, v247
    v_dot2c_f32_bf16 v137, v247, v247
    s_nop 2
    v_mov_b32 v139, v136
    s_nop 1
    v_permlane32_swap_b32 v136, v139
    s_nop 0
    v_add_f32 v136, v136, v139
    v_mov_b32 v139, v137
    s_nop 1
    v_permlane32_swap_b32 v137, v139
    s_nop 0
    v_add_f32 v137, v137, v139
    s_lshl_b32 s65, s64, 12
    s_lshl_b32 s66, s61, 9
    s_add_u32 s65, s65, s66
    s_lshl_b32 s66, s63, 8
    s_add_u32 s65, s65, s66
    s_add_u32 s65, s65, 0x1000000
    v_lshlrev_b32 v139, 3, v128
    buffer_store_dwordx2 v[136:137], v139, s[52:55], s65 offen sc1
    v_and_b32 v143, 15, v1
    v_lshlrev_b32 v143, 11, v143
    s_bfe_u32 s70, s40, 0x10001
    s_lshl_b32 s70, s70, 10
    s_lshl_b32 s71, s39, 7
    s_add_u32 s70, s70, s71
    s_lshl_b32 s71, s61, 3
    s_add_u32 s70, s70, s71
    s_and_b32 s71, s40, 1
    s_lshl_b32 s71, s71, 2
    s_add_u32 s70, s70, s71
    v_add_u32 v143, s70, v143
    s_xor_b32 s70, s38, 2
    s_lshl_b32 s70, s70, 12
    v_mov_b32 v140, s70
    v_and_b32 v141, 3, v1
    v_lshlrev_b32 v141, 12, v141
    s_waitcnt vmcnt(0)
    s_mov_b32 s93, 0x7fd0a502
    v_mov_b32 v142, s93
    ds_write_b32 v140, v142
    s_cmp_lg_u32 s38, 0
    s_cbranch_scc1 SD_51
SG_50:
    ds_read_b32 v142, v141
    s_waitcnt lgkmcnt(0)
    v_cmp_ne_u32 vcc, s93, v142
    s_cbranch_vccnz SG_50
    s_cmp_lg_u32 s38, 0
    s_cbranch_scc1 PUB_52
    s_mov_b32 s92, 0x1210000
    v_mov_b32 v142, s42
    buffer_store_dword v142, v143, s[52:55], s92 offen sc1
PUB_52:
SD_51:
    s_branch P3D_46
P3H_45:
    v_add_u32 v8, 0, v1
    v_mul_u32_u24 v9, 171, v8
    v_lshrrev_b32 v9, 11, v9
    v_mul_u32_u24 v10, 12, v9
    v_sub_u32 v10, v8, v10
    v_mul_u32_u24 v2, 2752, v9
    v_lshl_add_u32 v2, v10, 4, v2
    v_add_u32 v8, 64, v1
    v_mul_u32_u24 v9, 171, v8
    v_lshrrev_b32 v9, 11, v9
    v_mul_u32_u24 v10, 12, v9
    v_sub_u32 v10, v8, v10
    v_mul_u32_u24 v3, 2752, v9
    v_lshl_add_u32 v3, v10, 4, v3
    v_add_u32 v8, 128, v1
    v_mul_u32_u24 v9, 171, v8
    v_lshrrev_b32 v9, 11, v9
    v_mul_u32_u24 v10, 12, v9
    v_sub_u32 v10, v8, v10
    v_mul_u32_u24 v4, 2752, v9
    v_lshl_add_u32 v4, v10, 4, v4
    s_mov_b32 s44, s24
    s_mov_b32 s45, s25
    s_mov_b32 s46, 0x158000
    s_mov_b32 s47, 0x20000
    s_lshl_b32 s64, s41, 2
    s_add_u32 s64, s64, 8
    s_mul_i32 s70, s64, 3072
    s_add_u32 s70, s70, 65536
    s_mul_i32 s71, s64, 44032
    s_lshr_b32 s65, s40, 1
    s_mul_i32 s65, s65, 192
    s_add_u32 s71, s71, s65
    s_add_u32 m0, s70, 0
    s_add_u32 s65, s71, 0
    buffer_load_dwordx4 v2, s[44:47], s65 offen lds
    s_add_u32 m0, s70, 1024
    s_add_u32 s65, s71, 0
    buffer_load_dwordx4 v3, s[44:47], s65 offen lds
    s_add_u32 m0, s70, 2048
    s_add_u32 s65, s71, 0
    buffer_load_dwordx4 v4, s[44:47], s65 offen lds
    s_add_u32 m0, s70, 3072
    s_add_u32 s65, s71, 44032
    buffer_load_dwordx4 v2, s[44:47], s65 offen lds
    s_add_u32 m0, s70, 4096
    s_add_u32 s65, s71, 44032
    buffer_load_dwordx4 v3, s[44:47], s65 offen lds
    s_add_u32 m0, s70, 5120
    s_add_u32 s65, s71, 44032
    buffer_load_dwordx4 v4, s[44:47], s65 offen lds
    s_add_u32 m0, s70, 6144
    s_add_u32 s65, s71, 88064
    buffer_load_dwordx4 v2, s[44:47], s65 offen lds
    s_add_u32 m0, s70, 7168
    s_add_u32 s65, s71, 88064
    buffer_load_dwordx4 v3, s[44:47], s65 offen lds
    s_add_u32 m0, s70, 8192
    s_add_u32 s65, s71, 88064
    buffer_load_dwordx4 v4, s[44:47], s65 offen lds
    s_add_u32 m0, s70, 9216
    s_add_u32 s65, s71, 132096
    buffer_load_dwordx4 v2, s[44:47], s65 offen lds
    s_add_u32 m0, s70, 10240
    s_add_u32 s65, s71, 132096
    buffer_load_dwordx4 v3, s[44:47], s65 offen lds
    s_add_u32 m0, s70, 11264
    s_add_u32 s65, s71, 132096
    buffer_load_dwordx4 v4, s[44:47], s65 offen lds
    s_mov_b32 s48, s28
    s_mov_b32 s49, s29
    s_mov_b32 s50, 0x158000
    s_mov_b32 s51, 0x20000
    s_barrier
    v_lshrrev_b32 v8, 3, v1
    v_and_b32 v9, 7, v1
    v_bfe_u32 v10, v1, 4, 1
    v_lshlrev_b32 v10, 2, v10
    v_xor_b32 v9, v9, v10
    v_lshlrev_b32 v9, 4, v9
    v_mul_u32_u24 v5, 1024, v8
    v_add_u32 v5, v5, v9
    s_lshl_b32 s72, s41, 15
    s_lshl_b32 s65, s61, 7
    s_add_u32 s72, s72, s65
    s_lshl_b32 s73, s41, 12
    v_and_b32 v20, 15, v1
    v_lshrrev_b32 v21, 5, v1
    v_lshrrev_b32 v22, 2, v20
    v_lshl_add_u32 v22, v21, 2, v22
    v_mul_u32_u24 v22, 192, v22
    v_bfe_u32 v23, v1, 4, 1
    v_lshl_add_u32 v22, v23, 5, v22
    v_and_b32 v23, 3, v20
    v_lshl_add_u32 v22, v23, 3, v22
    s_min_u32 s74, s41, 2
    s_lshl_b32 s74, s74, 6
    s_add_u32 s74, s74, 65536
    v_add_u32 v13, s74, v22
    v_mov_b32 v14, 0x3f803f80
    v_mov_b32 v24, 0
    v_mov_b32 v25, 0
    v_mov_b32 v26, 0
    v_mov_b32 v27, 0
    v_add_u32 v15, 49152, v13
    ds_read_b64_tr_b16 v[32:33], v13 offset:0
    ds_read_b64_tr_b16 v[34:35], v13 offset:1536
    ds_read_b64_tr_b16 v[36:37], v13 offset:3072
    ds_read_b64_tr_b16 v[38:39], v13 offset:4608
    ds_read_b64_tr_b16 v[40:41], v13 offset:6144
    ds_read_b64_tr_b16 v[42:43], v13 offset:7680
    ds_read_b64_tr_b16 v[44:45], v13 offset:9216
    ds_read_b64_tr_b16 v[46:47], v13 offset:10752
    ds_read_b64_tr_b16 v[48:49], v13 offset:12288
    ds_read_b64_tr_b16 v[50:51], v13 offset:13824
    ds_read_b64_tr_b16 v[52:53], v13 offset:15360
    ds_read_b64_tr_b16 v[54:55], v13 offset:16896
    ds_read_b64_tr_b16 v[56:57], v13 offset:18432
    ds_read_b64_tr_b16 v[58:59], v13 offset:19968
    ds_read_b64_tr_b16 v[60:61], v13 offset:21504
    ds_read_b64_tr_b16 v[62:63], v13 offset:23040
    s_waitcnt lgkmcnt(14)
    v_dot2c_f32_bf16 v24, v14, v32
    v_dot2c_f32_bf16 v25, v14, v33
    v_dot2c_f32_bf16 v26, v14, v34
    v_dot2c_f32_bf16 v27, v14, v35
    s_waitcnt lgkmcnt(12)
    v_dot2c_f32_bf16 v24, v14, v36
    v_dot2c_f32_bf16 v25, v14, v37
    v_dot2c_f32_bf16 v26, v14, v38
    v_dot2c_f32_bf16 v27, v14, v39
    s_waitcnt lgkmcnt(10)
    v_dot2c_f32_bf16 v24, v14, v40
    v_dot2c_f32_bf16 v25, v14, v41
    v_dot2c_f32_bf16 v26, v14, v42
    v_dot2c_f32_bf16 v27, v14, v43
    s_waitcnt lgkmcnt(8)
    v_dot2c_f32_bf16 v24, v14, v44
    v_dot2c_f32_bf16 v25, v14, v45
    v_dot2c_f32_bf16 v26, v14, v46
    v_dot2c_f32_bf16 v27, v14, v47
    s_waitcnt lgkmcnt(6)
    v_dot2c_f32_bf16 v24, v14, v48
    v_dot2c_f32_bf16 v25, v14, v49
    v_dot2c_f32_bf16 v26, v14, v50
    v_dot2c_f32_bf16 v27, v14, v51
    s_waitcnt lgkmcnt(4)
    v_dot2c_f32_bf16 v24, v14, v52
    v_dot2c_f32_bf16 v25, v14, v53
    v_dot2c_f32_bf16 v26, v14, v54
    v_dot2c_f32_bf16 v27, v14, v55
    s_waitcnt lgkmcnt(2)
    v_dot2c_f32_bf16 v24, v14, v56
    v_dot2c_f32_bf16 v25, v14, v57
    v_dot2c_f32_bf16 v26, v14, v58
    v_dot2c_f32_bf16 v27, v14, v59
    s_waitcnt lgkmcnt(0)
    v_dot2c_f32_bf16 v24, v14, v60
    v_dot2c_f32_bf16 v25, v14, v61
    v_dot2c_f32_bf16 v26, v14, v62
    v_dot2c_f32_bf16 v27, v14, v63
    ds_read_b64_tr_b16 v[32:33], v15 offset:24576
    ds_read_b64_tr_b16 v[34:35], v15 offset:26112
    ds_read_b64_tr_b16 v[36:37], v15 offset:27648
    ds_read_b64_tr_b16 v[38:39], v15 offset:29184
    ds_read_b64_tr_b16 v[40:41], v15 offset:30720
    ds_read_b64_tr_b16 v[42:43], v15 offset:32256
    ds_read_b64_tr_b16 v[44:45], v15 offset:33792
    ds_read_b64_tr_b16 v[46:47], v15 offset:35328
    ds_read_b64_tr_b16 v[48:49], v15 offset:36864
    ds_read_b64_tr_b16 v[50:51], v15 offset:38400
    ds_read_b64_tr_b16 v[52:53], v15 offset:39936
    ds_read_b64_tr_b16 v[54:55], v15 offset:41472
    ds_read_b64_tr_b16 v[56:57], v15 offset:43008
    ds_read_b64_tr_b16 v[58:59], v15 offset:44544
    ds_read_b64_tr_b16 v[60:61], v15 offset:46080
    ds_read_b64_tr_b16 v[62:63], v15 offset:47616
    s_waitcnt lgkmcnt(14)
    v_dot2c_f32_bf16 v24, v14, v32
    v_dot2c_f32_bf16 v25, v14, v33
    v_dot2c_f32_bf16 v26, v14, v34
    v_dot2c_f32_bf16 v27, v14, v35
    s_waitcnt lgkmcnt(12)
    v_dot2c_f32_bf16 v24, v14, v36
    v_dot2c_f32_bf16 v25, v14, v37
    v_dot2c_f32_bf16 v26, v14, v38
    v_dot2c_f32_bf16 v27, v14, v39
    s_waitcnt lgkmcnt(10)
    v_dot2c_f32_bf16 v24, v14, v40
    v_dot2c_f32_bf16 v25, v14, v41
    v_dot2c_f32_bf16 v26, v14, v42
    v_dot2c_f32_bf16 v27, v14, v43
    s_waitcnt lgkmcnt(8)
    v_dot2c_f32_bf16 v24, v14, v44
    v_dot2c_f32_bf16 v25, v14, v45
    v_dot2c_f32_bf16 v26, v14, v46
    v_dot2c_f32_bf16 v27, v14, v47
    s_waitcnt lgkmcnt(6)
    v_dot2c_f32_bf16 v24, v14, v48
    v_dot2c_f32_bf16 v25, v14, v49
    v_dot2c_f32_bf16 v26, v14, v50
    v_dot2c_f32_bf16 v27, v14, v51
    s_waitcnt lgkmcnt(4)
    v_dot2c_f32_bf16 v24, v14, v52
    v_dot2c_f32_bf16 v25, v14, v53
    v_dot2c_f32_bf16 v26, v14, v54
    v_dot2c_f32_bf16 v27, v14, v55
    s_waitcnt lgkmcnt(2)
    v_dot2c_f32_bf16 v24, v14, v56
    v_dot2c_f32_bf16 v25, v14, v57
    v_dot2c_f32_bf16 v26, v14, v58
    v_dot2c_f32_bf16 v27, v14, v59
    s_waitcnt lgkmcnt(0)
    v_dot2c_f32_bf16 v24, v14, v60
    v_dot2c_f32_bf16 v25, v14, v61
    v_dot2c_f32_bf16 v26, v14, v62
    v_dot2c_f32_bf16 v27, v14, v63
    s_waitcnt vmcnt(0)
    s_barrier
    s_barrier
    ds_read_b64_tr_b16 v[32:33], v13 offset:24576
    ds_read_b64_tr_b16 v[34:35], v13 offset:26112
    ds_read_b64_tr_b16 v[36:37], v13 offset:27648
    ds_read_b64_tr_b16 v[38:39], v13 offset:29184
    ds_read_b64_tr_b16 v[40:41], v13 offset:30720
    ds_read_b64_tr_b16 v[42:43], v13 offset:32256
    ds_read_b64_tr_b16 v[44:45], v13 offset:33792
    ds_read_b64_tr_b16 v[46:47], v13 offset:35328
    ds_read_b64_tr_b16 v[48:49], v13 offset:36864
    ds_read_b64_tr_b16 v[50:51], v13 offset:38400
    ds_read_b64_tr_b16 v[52:53], v13 offset:39936
    ds_read_b64_tr_b16 v[54:55], v13 offset:41472
    ds_read_b64_tr_b16 v[56:57], v13 offset:43008
    ds_read_b64_tr_b16 v[58:59], v13 offset:44544
    ds_read_b64_tr_b16 v[60:61], v13 offset:46080
    ds_read_b64_tr_b16 v[62:63], v13 offset:47616
    s_waitcnt lgkmcnt(14)
    v_dot2c_f32_bf16 v24, v14, v32
    v_dot2c_f32_bf16 v25, v14, v33
    v_dot2c_f32_bf16 v26, v14, v34
    v_dot2c_f32_bf16 v27, v14, v35
    s_waitcnt lgkmcnt(12)
    v_dot2c_f32_bf16 v24, v14, v36
    v_dot2c_f32_bf16 v25, v14, v37
    v_dot2c_f32_bf16 v26, v14, v38
    v_dot2c_f32_bf16 v27, v14, v39
    s_waitcnt lgkmcnt(10)
    v_dot2c_f32_bf16 v24, v14, v40
    v_dot2c_f32_bf16 v25, v14, v41
    v_dot2c_f32_bf16 v26, v14, v42
    v_dot2c_f32_bf16 v27, v14, v43
    s_waitcnt lgkmcnt(8)
    v_dot2c_f32_bf16 v24, v14, v44
    v_dot2c_f32_bf16 v25, v14, v45
    v_dot2c_f32_bf16 v26, v14, v46
    v_dot2c_f32_bf16 v27, v14, v47
    s_waitcnt lgkmcnt(6)
    v_dot2c_f32_bf16 v24, v14, v48
    v_dot2c_f32_bf16 v25, v14, v49
    v_dot2c_f32_bf16 v26, v14, v50
    v_dot2c_f32_bf16 v27, v14, v51
    s_waitcnt lgkmcnt(4)
    v_dot2c_f32_bf16 v24, v14, v52
    v_dot2c_f32_bf16 v25, v14, v53
    v_dot2c_f32_bf16 v26, v14, v54
    v_dot2c_f32_bf16 v27, v14, v55
    s_waitcnt lgkmcnt(2)
    v_dot2c_f32_bf16 v24, v14, v56
    v_dot2c_f32_bf16 v25, v14, v57
    v_dot2c_f32_bf16 v26, v14, v58
    v_dot2c_f32_bf16 v27, v14, v59
    s_waitcnt lgkmcnt(0)
    v_dot2c_f32_bf16 v24, v14, v60
    v_dot2c_f32_bf16 v25, v14, v61
    v_dot2c_f32_bf16 v26, v14, v62
    v_dot2c_f32_bf16 v27, v14, v63
    ds_read_b64_tr_b16 v[32:33], v15 offset:0
    ds_read_b64_tr_b16 v[34:35], v15 offset:1536
    ds_read_b64_tr_b16 v[36:37], v15 offset:3072
    ds_read_b64_tr_b16 v[38:39], v15 offset:4608
    ds_read_b64_tr_b16 v[40:41], v15 offset:6144
    ds_read_b64_tr_b16 v[42:43], v15 offset:7680
    ds_read_b64_tr_b16 v[44:45], v15 offset:9216
    ds_read_b64_tr_b16 v[46:47], v15 offset:10752
    ds_read_b64_tr_b16 v[48:49], v15 offset:12288
    ds_read_b64_tr_b16 v[50:51], v15 offset:13824
    ds_read_b64_tr_b16 v[52:53], v15 offset:15360
    ds_read_b64_tr_b16 v[54:55], v15 offset:16896
    ds_read_b64_tr_b16 v[56:57], v15 offset:18432
    ds_read_b64_tr_b16 v[58:59], v15 offset:19968
    ds_read_b64_tr_b16 v[60:61], v15 offset:21504
    ds_read_b64_tr_b16 v[62:63], v15 offset:23040
    s_waitcnt lgkmcnt(14)
    v_dot2c_f32_bf16 v24, v14, v32
    v_dot2c_f32_bf16 v25, v14, v33
    v_dot2c_f32_bf16 v26, v14, v34
    v_dot2c_f32_bf16 v27, v14, v35
    s_waitcnt lgkmcnt(12)
    v_dot2c_f32_bf16 v24, v14, v36
    v_dot2c_f32_bf16 v25, v14, v37
    v_dot2c_f32_bf16 v26, v14, v38
    v_dot2c_f32_bf16 v27, v14, v39
    s_waitcnt lgkmcnt(10)
    v_dot2c_f32_bf16 v24, v14, v40
    v_dot2c_f32_bf16 v25, v14, v41
    v_dot2c_f32_bf16 v26, v14, v42
    v_dot2c_f32_bf16 v27, v14, v43
    s_waitcnt lgkmcnt(8)
    v_dot2c_f32_bf16 v24, v14, v44
    v_dot2c_f32_bf16 v25, v14, v45
    v_dot2c_f32_bf16 v26, v14, v46
    v_dot2c_f32_bf16 v27, v14, v47
    s_waitcnt lgkmcnt(6)
    v_dot2c_f32_bf16 v24, v14, v48
    v_dot2c_f32_bf16 v25, v14, v49
    v_dot2c_f32_bf16 v26, v14, v50
    v_dot2c_f32_bf16 v27, v14, v51
    s_waitcnt lgkmcnt(4)
    v_dot2c_f32_bf16 v24, v14, v52
    v_dot2c_f32_bf16 v25, v14, v53
    v_dot2c_f32_bf16 v26, v14, v54
    v_dot2c_f32_bf16 v27, v14, v55
    s_waitcnt lgkmcnt(2)
    v_dot2c_f32_bf16 v24, v14, v56
    v_dot2c_f32_bf16 v25, v14, v57
    v_dot2c_f32_bf16 v26, v14, v58
    v_dot2c_f32_bf16 v27, v14, v59
    s_waitcnt lgkmcnt(0)
    v_dot2c_f32_bf16 v24, v14, v60
    v_dot2c_f32_bf16 v25, v14, v61
    v_dot2c_f32_bf16 v26, v14, v62
    v_dot2c_f32_bf16 v27, v14, v63
    s_nop 2
    v_add_f32 v24, v24, v25
    v_add_f32 v26, v26, v27
    v_add_f32 v24, v24, v26
    v_mov_b32 v25, v24
    s_nop 1
    v_permlane32_swap_b32 v24, v25
    s_nop 0
    v_add_f32 v24, v24, v25
    v_and_b32 v26, 31, v1
    s_lshl_b32 s74, s41, 7
    v_lshl_add_u32 v26, v26, 2, s74
P3D_46:
    s_waitcnt lgkmcnt(0)
    s_barrier
P3Z_53:
    s_and_b32 s60, s40, 1
    s_lshl_b32 s62, s39, 1
    s_add_u32 s60, s60, s62
    s_lshr_b32 s61, s40, 1
    s_cmp_ge_u32 s38, 4
    s_cbranch_scc1 P4H_54
    s_cmp_ge_u32 s61, 15
    s_cbranch_scc1 P4I_56
    s_lshl_b32 s62, s60, 2
    s_add_u32 s62, s62, s38
    s_mov_b32 s56, s26
    s_mov_b32 s57, s27
    s_mov_b32 s58, 0xac0
    s_mov_b32 s59, 0x20000
    s_lshl_b32 s65, s62, 15
    s_add_u32 s65, s65, 0x800000
    s_add_u32 s44, s36, s65
    s_addc_u32 s45, s37, 0
    s_mov_b32 s46, 0x8000
    s_mov_b32 s47, 0x20000
    v_and_b32 v156, 31, v1
    v_lshrrev_b32 v157, 5, v1
    v_lshlrev_b32 v248, 4, v1
    v_lshlrev_b32 v159, 3, v157
    s_mul_i32 s66, s61, 192
    buffer_load_dwordx2 v[108:109], v159, s[56:59], s66 offen offset:0
    buffer_load_dwordx2 v[110:111], v159, s[56:59], s66 offen offset:16
    buffer_load_dwordx2 v[112:113], v159, s[56:59], s66 offen offset:32
    buffer_load_dwordx2 v[114:115], v159, s[56:59], s66 offen offset:48
    buffer_load_dwordx2 v[116:117], v159, s[56:59], s66 offen offset:64
    buffer_load_dwordx2 v[118:119], v159, s[56:59], s66 offen offset:80
    buffer_load_dwordx2 v[120:121], v159, s[56:59], s66 offen offset:96
    buffer_load_dwordx2 v[122:123], v159, s[56:59], s66 offen offset:112
    buffer_load_dwordx2 v[124:125], v159, s[56:59], s66 offen offset:128
    buffer_load_dwordx2 v[126:127], v159, s[56:59], s66 offen offset:144
    buffer_load_dwordx2 v[128:129], v159, s[56:59], s66 offen offset:160
    buffer_load_dwordx2 v[130:131], v159, s[56:59], s66 offen offset:176
    v_and_b32 v159, 15, v1
    v_lshrrev_b32 v249, 2, v159
    v_lshl_add_u32 v249, v157, 2, v249
    v_mul_u32_u24 v249, 192, v249
    v_bfe_u32 v250, v1, 4, 1
    v_lshl_add_u32 v249, v250, 5, v249
    v_and_b32 v250, 3, v159
    v_lshl_add_u32 v249, v250, 3, v249
    v_add_u32 v138, 65536, v249
    v_mov_b32 v2, 0
    v_mov_b32 v3, 0
    v_mov_b32 v4, 0
    v_mov_b32 v5, 0
    v_mov_b32 v6, 0
    v_mov_b32 v7, 0
    v_mov_b32 v8, 0
    v_mov_b32 v9, 0
    v_mov_b32 v10, 0
    v_mov_b32 v11, 0
    v_mov_b32 v12, 0
    v_mov_b32 v13, 0
    v_mov_b32 v14, 0
    v_mov_b32 v15, 0
    v_mov_b32 v16, 0
    v_mov_b32 v17, 0
    v_mov_b32 v18, 0
    v_mov_b32 v19, 0
    v_mov_b32 v20, 0
    v_mov_b32 v21, 0
    v_mov_b32 v22, 0
    v_mov_b32 v23, 0
    v_mov_b32 v24, 0
    v_mov_b32 v25, 0
    v_mov_b32 v26, 0
    v_mov_b32 v27, 0
    v_mov_b32 v28, 0
    v_mov_b32 v29, 0
    v_mov_b32 v30, 0
    v_mov_b32 v31, 0
    v_mov_b32 v32, 0
    v_mov_b32 v33, 0
    v_mov_b32 v34, 0
    v_mov_b32 v35, 0
    v_mov_b32 v36, 0
    v_mov_b32 v37, 0
    v_mov_b32 v38, 0
    v_mov_b32 v39, 0
    v_mov_b32 v40, 0
    v_mov_b32 v41, 0
    v_mov_b32 v42, 0
    v_mov_b32 v43, 0
    v_mov_b32 v44, 0
    v_mov_b32 v45, 0
    v_mov_b32 v46, 0
    v_mov_b32 v47, 0
    v_mov_b32 v48, 0
    v_mov_b32 v49, 0
    s_and_b32 s63, s61, 3
    s_mul_i32 s65, s63, 24576
    v_add_u32 v132, s65, v138
    s_mov_b32 s64, 0
    v_lshlrev_b32 v159, 3, v156
    v_lshl_add_u32 v159, v157, 8, v159
    v_and_b32 v249, 15, v1
    v_lshlrev_b32 v249, 2, v249
    s_lshl_b32 s65, s2, 7
    v_add_u32 v249, s65, v249
    s_cmp_lg_u32 s38, 0
    s_cbranch_scc1 POD_59
    s_mov_b32 s92, 0x1210000
    s_mov_b32 s43, 300000
POL_58:
    buffer_load_dword v250, v249, s[52:55], s92 offen sc1
    s_waitcnt vmcnt(0)
    v_cmp_ne_u32 vcc, s42, v250
    s_cbranch_vccz POD_59
    s_sub_u32 s43, s43, 1
    s_cbranch_scc0 POL_58
POD_59:
    s_barrier
    s_lshl_b32 s65, s62, 12
    s_add_u32 s65, s65, 0x1000000
    buffer_load_dwordx2 v[140:141], v159, s[52:55], s65 offen offset:0 sc1
    buffer_load_dwordx2 v[142:143], v159, s[52:55], s65 offen offset:512 sc1
    buffer_load_dwordx2 v[144:145], v159, s[52:55], s65 offen offset:1024 sc1
    buffer_load_dwordx2 v[146:147], v159, s[52:55], s65 offen offset:1536 sc1
    buffer_load_dwordx2 v[148:149], v159, s[52:55], s65 offen offset:2048 sc1
    buffer_load_dwordx2 v[150:151], v159, s[52:55], s65 offen offset:2560 sc1
    buffer_load_dwordx2 v[152:153], v159, s[52:55], s65 offen offset:3072 sc1
    buffer_load_dwordx2 v[154:155], v159, s[52:55], s65 offen offset:3584 sc1
    s_lshl_b32 s66, s63, 13
    s_add_u32 s67, s66, 4096
    buffer_load_dwordx4 v[52:55], v248, s[44:47], s66 offen offset:0 sc1
    buffer_load_dwordx4 v[56:59], v248, s[44:47], s66 offen offset:1024 sc1
    buffer_load_dwordx4 v[60:63], v248, s[44:47], s66 offen offset:2048 sc1
    buffer_load_dwordx4 v[64:67], v248, s[44:47], s66 offen offset:3072 sc1
    buffer_load_dwordx4 v[68:71], v248, s[44:47], s67 offen offset:0 sc1
    buffer_load_dwordx4 v[72:75], v248, s[44:47], s67 offen offset:1024 sc1
    buffer_load_dwordx4 v[76:79], v248, s[44:47], s67 offen offset:2048 sc1
    buffer_load_dwordx4 v[80:83], v248, s[44:47], s67 offen offset:3072 sc1
    ds_read_b64_tr_b16 v[84:85], v132 offset:0
    ds_read_b64_tr_b16 v[86:87], v132 offset:1536
    ds_read_b64_tr_b16 v[88:89], v132 offset:64
    ds_read_b64_tr_b16 v[90:91], v132 offset:1600
    ds_read_b64_tr_b16 v[92:93], v132 offset:128
    ds_read_b64_tr_b16 v[94:95], v132 offset:1664
    ds_read_b64_tr_b16 v[96:97], v132 offset:3072
    ds_read_b64_tr_b16 v[98:99], v132 offset:4608
    ds_read_b64_tr_b16 v[100:101], v132 offset:3136
    ds_read_b64_tr_b16 v[102:103], v132 offset:4672
    ds_read_b64_tr_b16 v[104:105], v132 offset:3200
    ds_read_b64_tr_b16 v[106:107], v132 offset:4736
P4L_60:
    s_add_u32 s63, s63, 1
    s_and_b32 s63, s63, 3
    s_mul_i32 s65, s63, 24576
    v_add_u32 v133, s65, v138
    s_lshl_b32 s66, s63, 13
    s_cmp_eq_u32 s64, 3
    s_cselect_b32 s66, 0x100000, s66
    s_add_u32 s67, s66, 4096
    s_waitcnt vmcnt(7) lgkmcnt(6)
    v_mfma_f32_32x32x16_bf16 v[2:17], v[84:87], v[52:55], v[2:17]
    ds_read_b64_tr_b16 v[192:193], v132 offset:6144
    ds_read_b64_tr_b16 v[194:195], v132 offset:7680
    v_mfma_f32_32x32x16_bf16 v[18:33], v[88:91], v[52:55], v[18:33]
    ds_read_b64_tr_b16 v[196:197], v132 offset:6208
    ds_read_b64_tr_b16 v[198:199], v132 offset:7744
    v_mfma_f32_32x32x16_bf16 v[34:49], v[92:95], v[52:55], v[34:49]
    ds_read_b64_tr_b16 v[200:201], v132 offset:6272
    ds_read_b64_tr_b16 v[202:203], v132 offset:7808
    buffer_load_dwordx4 v[52:55], v248, s[44:47], s66 offen offset:0 sc1
    s_waitcnt vmcnt(7) lgkmcnt(6)
    v_mfma_f32_32x32x16_bf16 v[2:17], v[96:99], v[56:59], v[2:17]
    ds_read_b64_tr_b16 v[204:205], v132 offset:9216
    ds_read_b64_tr_b16 v[206:207], v132 offset:10752
    v_mfma_f32_32x32x16_bf16 v[18:33], v[100:103], v[56:59], v[18:33]
    ds_read_b64_tr_b16 v[208:209], v132 offset:9280
    ds_read_b64_tr_b16 v[210:211], v132 offset:10816
    v_mfma_f32_32x32x16_bf16 v[34:49], v[104:107], v[56:59], v[34:49]
    ds_read_b64_tr_b16 v[212:213], v132 offset:9344
    ds_read_b64_tr_b16 v[214:215], v132 offset:10880
    buffer_load_dwordx4 v[56:59], v248, s[44:47], s66 offen offset:1024 sc1
    s_waitcnt vmcnt(7) lgkmcnt(6)
    v_mfma_f32_32x32x16_bf16 v[2:17], v[192:195], v[60:63], v[2:17]
    ds_read_b64_tr_b16 v[84:85], v132 offset:12288
    ds_read_b64_tr_b16 v[86:87], v132 offset:13824
    v_mfma_f32_32x32x16_bf16 v[18:33], v[196:199], v[60:63], v[18:33]
    ds_read_b64_tr_b16 v[88:89], v132 offset:12352
    ds_read_b64_tr_b16 v[90:91], v132 offset:13888
    v_mfma_f32_32x32x16_bf16 v[34:49], v[200:203], v[60:63], v[34:49]
    ds_read_b64_tr_b16 v[92:93], v132 offset:12416
    ds_read_b64_tr_b16 v[94:95], v132 offset:13952
    buffer_load_dwordx4 v[60:63], v248, s[44:47], s66 offen offset:2048 sc1
    s_waitcnt vmcnt(7) lgkmcnt(6)
    v_mfma_f32_32x32x16_bf16 v[2:17], v[204:207], v[64:67], v[2:17]
    ds_read_b64_tr_b16 v[96:97], v132 offset:15360
    ds_read_b64_tr_b16 v[98:99], v132 offset:16896
    v_mfma_f32_32x32x16_bf16 v[18:33], v[208:211], v[64:67], v[18:33]
    ds_read_b64_tr_b16 v[100:101], v132 offset:15424
    ds_read_b64_tr_b16 v[102:103], v132 offset:16960
    v_mfma_f32_32x32x16_bf16 v[34:49], v[212:215], v[64:67], v[34:49]
    ds_read_b64_tr_b16 v[104:105], v132 offset:15488
    ds_read_b64_tr_b16 v[106:107], v132 offset:17024
    buffer_load_dwordx4 v[64:67], v248, s[44:47], s66 offen offset:3072 sc1
    s_waitcnt vmcnt(7) lgkmcnt(6)
    v_mfma_f32_32x32x16_bf16 v[2:17], v[84:87], v[68:71], v[2:17]
    ds_read_b64_tr_b16 v[192:193], v132 offset:18432
    ds_read_b64_tr_b16 v[194:195], v132 offset:19968
    v_mfma_f32_32x32x16_bf16 v[18:33], v[88:91], v[68:71], v[18:33]
    ds_read_b64_tr_b16 v[196:197], v132 offset:18496
    ds_read_b64_tr_b16 v[198:199], v132 offset:20032
    v_mfma_f32_32x32x16_bf16 v[34:49], v[92:95], v[68:71], v[34:49]
    ds_read_b64_tr_b16 v[200:201], v132 offset:18560
    ds_read_b64_tr_b16 v[202:203], v132 offset:20096
    buffer_load_dwordx4 v[68:71], v248, s[44:47], s67 offen offset:0 sc1
    s_waitcnt vmcnt(7) lgkmcnt(6)
    v_mfma_f32_32x32x16_bf16 v[2:17], v[96:99], v[72:75], v[2:17]
    ds_read_b64_tr_b16 v[204:205], v132 offset:21504
    ds_read_b64_tr_b16 v[206:207], v132 offset:23040
    v_mfma_f32_32x32x16_bf16 v[18:33], v[100:103], v[72:75], v[18:33]
    ds_read_b64_tr_b16 v[208:209], v132 offset:21568
    ds_read_b64_tr_b16 v[210:211], v132 offset:23104
    v_mfma_f32_32x32x16_bf16 v[34:49], v[104:107], v[72:75], v[34:49]
    ds_read_b64_tr_b16 v[212:213], v132 offset:21632
    ds_read_b64_tr_b16 v[214:215], v132 offset:23168
    buffer_load_dwordx4 v[72:75], v248, s[44:47], s67 offen offset:1024 sc1
    s_waitcnt vmcnt(7) lgkmcnt(6)
    v_mfma_f32_32x32x16_bf16 v[2:17], v[192:195], v[76:79], v[2:17]
    ds_read_b64_tr_b16 v[84:85], v133 offset:0
    ds_read_b64_tr_b16 v[86:87], v133 offset:1536
    v_mfma_f32_32x32x16_bf16 v[18:33], v[196:199], v[76:79], v[18:33]
    ds_read_b64_tr_b16 v[88:89], v133 offset:64
    ds_read_b64_tr_b16 v[90:91], v133 offset:1600
    v_mfma_f32_32x32x16_bf16 v[34:49], v[200:203], v[76:79], v[34:49]
    ds_read_b64_tr_b16 v[92:93], v133 offset:128
    ds_read_b64_tr_b16 v[94:95], v133 offset:1664
    buffer_load_dwordx4 v[76:79], v248, s[44:47], s67 offen offset:2048 sc1
    s_waitcnt vmcnt(7) lgkmcnt(6)
    v_mfma_f32_32x32x16_bf16 v[2:17], v[204:207], v[80:83], v[2:17]
    ds_read_b64_tr_b16 v[96:97], v133 offset:3072
    ds_read_b64_tr_b16 v[98:99], v133 offset:4608
    v_mfma_f32_32x32x16_bf16 v[18:33], v[208:211], v[80:83], v[18:33]
    ds_read_b64_tr_b16 v[100:101], v133 offset:3136
    ds_read_b64_tr_b16 v[102:103], v133 offset:4672
    v_mfma_f32_32x32x16_bf16 v[34:49], v[212:215], v[80:83], v[34:49]
    ds_read_b64_tr_b16 v[104:105], v133 offset:3200
    ds_read_b64_tr_b16 v[106:107], v133 offset:4736
    buffer_load_dwordx4 v[80:83], v248, s[44:47], s67 offen offset:3072 sc1
    v_mov_b32 v132, v133
    s_add_u32 s64, s64, 1
    s_cmp_lt_u32 s64, 4
    s_cbranch_scc1 P4L_60
    s_waitcnt lgkmcnt(0)
    s_barrier
    v_lshlrev_b32 v158, 4, v157
    ds_read_b128 v[160:163], v158 offset:0
    ds_read_b128 v[164:167], v158 offset:32
    ds_read_b128 v[168:171], v158 offset:64
    ds_read_b128 v[172:175], v158 offset:96
    ds_read_b128 v[176:179], v158 offset:128
    ds_read_b128 v[180:183], v158 offset:160
    ds_read_b128 v[184:187], v158 offset:192
    ds_read_b128 v[188:191], v158 offset:224
    ds_read_b128 v[192:195], v158 offset:256
    ds_read_b128 v[196:199], v158 offset:288
    ds_read_b128 v[200:203], v158 offset:320
    ds_read_b128 v[204:207], v158 offset:352
    v_add_f32 v252, v140, v142
    v_add_f32 v253, v141, v143
    v_add_f32 v252, v252, v144
    v_add_f32 v253, v253, v145
    v_add_f32 v252, v252, v146
    v_add_f32 v253, v253, v147
    v_add_f32 v252, v252, v148
    v_add_f32 v253, v253, v149
    v_add_f32 v252, v252, v150
    v_add_f32 v253, v253, v151
    v_add_f32 v252, v252, v152
    v_add_f32 v253, v253, v153
    v_add_f32 v252, v252, v154
    v_add_f32 v253, v253, v155
    s_waitcnt lgkmcnt(0)
    s_barrier
    v_mov_b32 v250, v252
    s_nop 1
    v_permlane32_swap_b32 v252, v250
    s_nop 0
    v_add_f32 v252, v252, v250
    v_mov_b32 v250, v253
    s_nop 1
    v_permlane32_swap_b32 v253, v250
    s_nop 0
    v_add_f32 v253, v253, v250
    v_mul_f32 v252, 0x3b000000, v252
    v_mul_f32 v250, 0x3b000000, v253
    v_fma_f32 v250, -v252, v252, v250
    v_add_f32 v250, 0x3727c5ac, v250
    v_rsq_f32 v250, v250
    s_nop 0
    v_mul_f32 v251, v252, v250
    s_waitcnt vmcnt(0)
    v_mov_b32 v52, 0xc0135761
    v_mov_b32 v53, 0xc0135761
    v_mov_b32 v54, 0xbdd2d3e8
    v_mov_b32 v55, 0xbdd2d3e8
    v_mov_b32 v56, 1.0
    v_mov_b32 v57, 1.0
    v_mov_b32 v58, v250
    v_mov_b32 v59, v250
    v_sub_f32 v60, 0, v251
    v_sub_f32 v61, 0, v251
    s_mul_i32 s65, s62, 88064
    s_mul_i32 s66, s61, 6144
    s_add_u32 s65, s65, s66
    s_add_u32 s65, s65, 0xa00000
    v_lshlrev_b32 v64, 16, v108
    v_and_b32 v65, 0xffff0000, v108
    v_lshlrev_b32 v66, 16, v109
    v_and_b32 v67, 0xffff0000, v109
    v_lshlrev_b32 v68, 16, v110
    v_and_b32 v69, 0xffff0000, v110
    v_lshlrev_b32 v70, 16, v111
    v_and_b32 v71, 0xffff0000, v111
    v_pk_fma_f32 v[64:65], v[160:161], v[60:61], v[64:65]
    v_pk_fma_f32 v[66:67], v[162:163], v[60:61], v[66:67]
    v_pk_fma_f32 v[68:69], v[164:165], v[60:61], v[68:69]
    v_pk_fma_f32 v[70:71], v[166:167], v[60:61], v[70:71]
    v_pk_fma_f32 v[2:3], v[2:3], v[58:59], v[64:65]
    v_pk_fma_f32 v[4:5], v[4:5], v[58:59], v[66:67]
    v_pk_fma_f32 v[6:7], v[6:7], v[58:59], v[68:69]
    v_pk_fma_f32 v[8:9], v[8:9], v[58:59], v[70:71]
    v_pk_mul_f32 v[72:73], v[2:3], v[2:3]
    v_pk_mul_f32 v[74:75], v[4:5], v[4:5]
    v_pk_mul_f32 v[76:77], v[6:7], v[6:7]
    v_pk_mul_f32 v[78:79], v[8:9], v[8:9]
    v_pk_fma_f32 v[72:73], v[72:73], v[54:55], v[52:53]
    v_pk_fma_f32 v[74:75], v[74:75], v[54:55], v[52:53]
    v_pk_fma_f32 v[76:77], v[76:77], v[54:55], v[52:53]
    v_pk_fma_f32 v[78:79], v[78:79], v[54:55], v[52:53]
    v_pk_mul_f32 v[72:73], v[2:3], v[72:73]
    v_pk_mul_f32 v[74:75], v[4:5], v[74:75]
    v_pk_mul_f32 v[76:77], v[6:7], v[76:77]
    v_pk_mul_f32 v[78:79], v[8:9], v[78:79]
    v_exp_f32 v72, v72
    v_exp_f32 v73, v73
    v_exp_f32 v74, v74
    v_exp_f32 v75, v75
    v_exp_f32 v76, v76
    v_exp_f32 v77, v77
    v_exp_f32 v78, v78
    v_exp_f32 v79, v79
    v_pk_add_f32 v[72:73], v[72:73], v[56:57]
    v_pk_add_f32 v[74:75], v[74:75], v[56:57]
    v_pk_add_f32 v[76:77], v[76:77], v[56:57]
    v_pk_add_f32 v[78:79], v[78:79], v[56:57]
    v_rcp_f32 v72, v72
    v_rcp_f32 v73, v73
    v_rcp_f32 v74, v74
    v_rcp_f32 v75, v75
    v_rcp_f32 v76, v76
    v_rcp_f32 v77, v77
    v_rcp_f32 v78, v78
    v_rcp_f32 v79, v79
    v_pk_mul_f32 v[2:3], v[2:3], v[72:73]
    v_pk_mul_f32 v[4:5], v[4:5], v[74:75]
    v_pk_mul_f32 v[6:7], v[6:7], v[76:77]
    v_pk_mul_f32 v[8:9], v[8:9], v[78:79]
    v_cvt_pk_bf16_f32 v208, v2, v3
    v_cvt_pk_bf16_f32 v209, v4, v5
    v_cvt_pk_bf16_f32 v210, v6, v7
    v_cvt_pk_bf16_f32 v211, v8, v9
    v_lshlrev_b32 v64, 16, v112
    v_and_b32 v65, 0xffff0000, v112
    v_lshlrev_b32 v66, 16, v113
    v_and_b32 v67, 0xffff0000, v113
    v_lshlrev_b32 v68, 16, v114
    v_and_b32 v69, 0xffff0000, v114
    v_lshlrev_b32 v70, 16, v115
    v_and_b32 v71, 0xffff0000, v115
    v_pk_fma_f32 v[64:65], v[168:169], v[60:61], v[64:65]
    v_pk_fma_f32 v[66:67], v[170:171], v[60:61], v[66:67]
    v_pk_fma_f32 v[68:69], v[172:173], v[60:61], v[68:69]
    v_pk_fma_f32 v[70:71], v[174:175], v[60:61], v[70:71]
    v_pk_fma_f32 v[10:11], v[10:11], v[58:59], v[64:65]
    v_pk_fma_f32 v[12:13], v[12:13], v[58:59], v[66:67]
    v_pk_fma_f32 v[14:15], v[14:15], v[58:59], v[68:69]
    v_pk_fma_f32 v[16:17], v[16:17], v[58:59], v[70:71]
    v_pk_mul_f32 v[72:73], v[10:11], v[10:11]
    v_pk_mul_f32 v[74:75], v[12:13], v[12:13]
    v_pk_mul_f32 v[76:77], v[14:15], v[14:15]
    v_pk_mul_f32 v[78:79], v[16:17], v[16:17]
    v_pk_fma_f32 v[72:73], v[72:73], v[54:55], v[52:53]
    v_pk_fma_f32 v[74:75], v[74:75], v[54:55], v[52:53]
    v_pk_fma_f32 v[76:77], v[76:77], v[54:55], v[52:53]
    v_pk_fma_f32 v[78:79], v[78:79], v[54:55], v[52:53]
    v_pk_mul_f32 v[72:73], v[10:11], v[72:73]
    v_pk_mul_f32 v[74:75], v[12:13], v[74:75]
    v_pk_mul_f32 v[76:77], v[14:15], v[76:77]
    v_pk_mul_f32 v[78:79], v[16:17], v[78:79]
    v_exp_f32 v72, v72
    v_exp_f32 v73, v73
    v_exp_f32 v74, v74
    v_exp_f32 v75, v75
    v_exp_f32 v76, v76
    v_exp_f32 v77, v77
    v_exp_f32 v78, v78
    v_exp_f32 v79, v79
    v_pk_add_f32 v[72:73], v[72:73], v[56:57]
    v_pk_add_f32 v[74:75], v[74:75], v[56:57]
    v_pk_add_f32 v[76:77], v[76:77], v[56:57]
    v_pk_add_f32 v[78:79], v[78:79], v[56:57]
    v_rcp_f32 v72, v72
    v_rcp_f32 v73, v73
    v_rcp_f32 v74, v74
    v_rcp_f32 v75, v75
    v_rcp_f32 v76, v76
    v_rcp_f32 v77, v77
    v_rcp_f32 v78, v78
    v_rcp_f32 v79, v79
    v_pk_mul_f32 v[10:11], v[10:11], v[72:73]
    v_pk_mul_f32 v[12:13], v[12:13], v[74:75]
    v_pk_mul_f32 v[14:15], v[14:15], v[76:77]
    v_pk_mul_f32 v[16:17], v[16:17], v[78:79]
    v_cvt_pk_bf16_f32 v212, v10, v11
    v_cvt_pk_bf16_f32 v213, v12, v13
    v_cvt_pk_bf16_f32 v214, v14, v15
    v_cvt_pk_bf16_f32 v215, v16, v17
    buffer_store_dwordx4 v[208:211], v248, s[52:55], s65 offen offset:0 sc1
    buffer_store_dwordx4 v[212:215], v248, s[52:55], s65 offen offset:1024 sc1
    s_cmp_eq_u32 s61, 14
    s_cbranch_scc1 P4S_57
    v_lshlrev_b32 v64, 16, v116
    v_and_b32 v65, 0xffff0000, v116
    v_lshlrev_b32 v66, 16, v117
    v_and_b32 v67, 0xffff0000, v117
    v_lshlrev_b32 v68, 16, v118
    v_and_b32 v69, 0xffff0000, v118
    v_lshlrev_b32 v70, 16, v119
    v_and_b32 v71, 0xffff0000, v119
    v_pk_fma_f32 v[64:65], v[176:177], v[60:61], v[64:65]
    v_pk_fma_f32 v[66:67], v[178:179], v[60:61], v[66:67]
    v_pk_fma_f32 v[68:69], v[180:181], v[60:61], v[68:69]
    v_pk_fma_f32 v[70:71], v[182:183], v[60:61], v[70:71]
    v_pk_fma_f32 v[18:19], v[18:19], v[58:59], v[64:65]
    v_pk_fma_f32 v[20:21], v[20:21], v[58:59], v[66:67]
    v_pk_fma_f32 v[22:23], v[22:23], v[58:59], v[68:69]
    v_pk_fma_f32 v[24:25], v[24:25], v[58:59], v[70:71]
    v_pk_mul_f32 v[72:73], v[18:19], v[18:19]
    v_pk_mul_f32 v[74:75], v[20:21], v[20:21]
    v_pk_mul_f32 v[76:77], v[22:23], v[22:23]
    v_pk_mul_f32 v[78:79], v[24:25], v[24:25]
    v_pk_fma_f32 v[72:73], v[72:73], v[54:55], v[52:53]
    v_pk_fma_f32 v[74:75], v[74:75], v[54:55], v[52:53]
    v_pk_fma_f32 v[76:77], v[76:77], v[54:55], v[52:53]
    v_pk_fma_f32 v[78:79], v[78:79], v[54:55], v[52:53]
    v_pk_mul_f32 v[72:73], v[18:19], v[72:73]
    v_pk_mul_f32 v[74:75], v[20:21], v[74:75]
    v_pk_mul_f32 v[76:77], v[22:23], v[76:77]
    v_pk_mul_f32 v[78:79], v[24:25], v[78:79]
    v_exp_f32 v72, v72
    v_exp_f32 v73, v73
    v_exp_f32 v74, v74
    v_exp_f32 v75, v75
    v_exp_f32 v76, v76
    v_exp_f32 v77, v77
    v_exp_f32 v78, v78
    v_exp_f32 v79, v79
    v_pk_add_f32 v[72:73], v[72:73], v[56:57]
    v_pk_add_f32 v[74:75], v[74:75], v[56:57]
    v_pk_add_f32 v[76:77], v[76:77], v[56:57]
    v_pk_add_f32 v[78:79], v[78:79], v[56:57]
    v_rcp_f32 v72, v72
    v_rcp_f32 v73, v73
    v_rcp_f32 v74, v74
    v_rcp_f32 v75, v75
    v_rcp_f32 v76, v76
    v_rcp_f32 v77, v77
    v_rcp_f32 v78, v78
    v_rcp_f32 v79, v79
    v_pk_mul_f32 v[18:19], v[18:19], v[72:73]
    v_pk_mul_f32 v[20:21], v[20:21], v[74:75]
    v_pk_mul_f32 v[22:23], v[22:23], v[76:77]
    v_pk_mul_f32 v[24:25], v[24:25], v[78:79]
    v_cvt_pk_bf16_f32 v216, v18, v19
    v_cvt_pk_bf16_f32 v217, v20, v21
    v_cvt_pk_bf16_f32 v218, v22, v23
    v_cvt_pk_bf16_f32 v219, v24, v25
    v_lshlrev_b32 v64, 16, v120
    v_and_b32 v65, 0xffff0000, v120
    v_lshlrev_b32 v66, 16, v121
    v_and_b32 v67, 0xffff0000, v121
    v_lshlrev_b32 v68, 16, v122
    v_and_b32 v69, 0xffff0000, v122
    v_lshlrev_b32 v70, 16, v123
    v_and_b32 v71, 0xffff0000, v123
    v_pk_fma_f32 v[64:65], v[184:185], v[60:61], v[64:65]
    v_pk_fma_f32 v[66:67], v[186:187], v[60:61], v[66:67]
    v_pk_fma_f32 v[68:69], v[188:189], v[60:61], v[68:69]
    v_pk_fma_f32 v[70:71], v[190:191], v[60:61], v[70:71]
    v_pk_fma_f32 v[26:27], v[26:27], v[58:59], v[64:65]
    v_pk_fma_f32 v[28:29], v[28:29], v[58:59], v[66:67]
    v_pk_fma_f32 v[30:31], v[30:31], v[58:59], v[68:69]
    v_pk_fma_f32 v[32:33], v[32:33], v[58:59], v[70:71]
    v_pk_mul_f32 v[72:73], v[26:27], v[26:27]
    v_pk_mul_f32 v[74:75], v[28:29], v[28:29]
    v_pk_mul_f32 v[76:77], v[30:31], v[30:31]
    v_pk_mul_f32 v[78:79], v[32:33], v[32:33]
    v_pk_fma_f32 v[72:73], v[72:73], v[54:55], v[52:53]
    v_pk_fma_f32 v[74:75], v[74:75], v[54:55], v[52:53]
    v_pk_fma_f32 v[76:77], v[76:77], v[54:55], v[52:53]
    v_pk_fma_f32 v[78:79], v[78:79], v[54:55], v[52:53]
    v_pk_mul_f32 v[72:73], v[26:27], v[72:73]
    v_pk_mul_f32 v[74:75], v[28:29], v[74:75]
    v_pk_mul_f32 v[76:77], v[30:31], v[76:77]
    v_pk_mul_f32 v[78:79], v[32:33], v[78:79]
    v_exp_f32 v72, v72
    v_exp_f32 v73, v73
    v_exp_f32 v74, v74
    v_exp_f32 v75, v75
    v_exp_f32 v76, v76
    v_exp_f32 v77, v77
    v_exp_f32 v78, v78
    v_exp_f32 v79, v79
    v_pk_add_f32 v[72:73], v[72:73], v[56:57]
    v_pk_add_f32 v[74:75], v[74:75], v[56:57]
    v_pk_add_f32 v[76:77], v[76:77], v[56:57]
    v_pk_add_f32 v[78:79], v[78:79], v[56:57]
    v_rcp_f32 v72, v72
    v_rcp_f32 v73, v73
    v_rcp_f32 v74, v74
    v_rcp_f32 v75, v75
    v_rcp_f32 v76, v76
    v_rcp_f32 v77, v77
    v_rcp_f32 v78, v78
    v_rcp_f32 v79, v79
    v_pk_mul_f32 v[26:27], v[26:27], v[72:73]
    v_pk_mul_f32 v[28:29], v[28:29], v[74:75]
    v_pk_mul_f32 v[30:31], v[30:31], v[76:77]
    v_pk_mul_f32 v[32:33], v[32:33], v[78:79]
    v_cvt_pk_bf16_f32 v220, v26, v27
    v_cvt_pk_bf16_f32 v221, v28, v29
    v_cvt_pk_bf16_f32 v222, v30, v31
    v_cvt_pk_bf16_f32 v223, v32, v33
    buffer_store_dwordx4 v[216:219], v248, s[52:55], s65 offen offset:2048 sc1
    buffer_store_dwordx4 v[220:223], v248, s[52:55], s65 offen offset:3072 sc1
    v_lshlrev_b32 v64, 16, v124
    v_and_b32 v65, 0xffff0000, v124
    v_lshlrev_b32 v66, 16, v125
    v_and_b32 v67, 0xffff0000, v125
    v_lshlrev_b32 v68, 16, v126
    v_and_b32 v69, 0xffff0000, v126
    v_lshlrev_b32 v70, 16, v127
    v_and_b32 v71, 0xffff0000, v127
    v_pk_fma_f32 v[64:65], v[192:193], v[60:61], v[64:65]
    v_pk_fma_f32 v[66:67], v[194:195], v[60:61], v[66:67]
    v_pk_fma_f32 v[68:69], v[196:197], v[60:61], v[68:69]
    v_pk_fma_f32 v[70:71], v[198:199], v[60:61], v[70:71]
    v_pk_fma_f32 v[34:35], v[34:35], v[58:59], v[64:65]
    v_pk_fma_f32 v[36:37], v[36:37], v[58:59], v[66:67]
    v_pk_fma_f32 v[38:39], v[38:39], v[58:59], v[68:69]
    v_pk_fma_f32 v[40:41], v[40:41], v[58:59], v[70:71]
    v_pk_mul_f32 v[72:73], v[34:35], v[34:35]
    v_pk_mul_f32 v[74:75], v[36:37], v[36:37]
    v_pk_mul_f32 v[76:77], v[38:39], v[38:39]
    v_pk_mul_f32 v[78:79], v[40:41], v[40:41]
    v_pk_fma_f32 v[72:73], v[72:73], v[54:55], v[52:53]
    v_pk_fma_f32 v[74:75], v[74:75], v[54:55], v[52:53]
    v_pk_fma_f32 v[76:77], v[76:77], v[54:55], v[52:53]
    v_pk_fma_f32 v[78:79], v[78:79], v[54:55], v[52:53]
    v_pk_mul_f32 v[72:73], v[34:35], v[72:73]
    v_pk_mul_f32 v[74:75], v[36:37], v[74:75]
    v_pk_mul_f32 v[76:77], v[38:39], v[76:77]
    v_pk_mul_f32 v[78:79], v[40:41], v[78:79]
    v_exp_f32 v72, v72
    v_exp_f32 v73, v73
    v_exp_f32 v74, v74
    v_exp_f32 v75, v75
    v_exp_f32 v76, v76
    v_exp_f32 v77, v77
    v_exp_f32 v78, v78
    v_exp_f32 v79, v79
    v_pk_add_f32 v[72:73], v[72:73], v[56:57]
    v_pk_add_f32 v[74:75], v[74:75], v[56:57]
    v_pk_add_f32 v[76:77], v[76:77], v[56:57]
    v_pk_add_f32 v[78:79], v[78:79], v[56:57]
    v_rcp_f32 v72, v72
    v_rcp_f32 v73, v73
    v_rcp_f32 v74, v74
    v_rcp_f32 v75, v75
    v_rcp_f32 v76, v76
    v_rcp_f32 v77, v77
    v_rcp_f32 v78, v78
    v_rcp_f32 v79, v79
    v_pk_mul_f32 v[34:35], v[34:35], v[72:73]
    v_pk_mul_f32 v[36:37], v[36:37], v[74:75]
    v_pk_mul_f32 v[38:39], v[38:39], v[76:77]
    v_pk_mul_f32 v[40:41], v[40:41], v[78:79]
    v_cvt_pk_bf16_f32 v208, v34, v35
    v_cvt_pk_bf16_f32 v209, v36, v37
    v_cvt_pk_bf16_f32 v210, v38, v39
    v_cvt_pk_bf16_f32 v211, v40, v41
    v_lshlrev_b32 v64, 16, v128
    v_and_b32 v65, 0xffff0000, v128
    v_lshlrev_b32 v66, 16, v129
    v_and_b32 v67, 0xffff0000, v129
    v_lshlrev_b32 v68, 16, v130
    v_and_b32 v69, 0xffff0000, v130
    v_lshlrev_b32 v70, 16, v131
    v_and_b32 v71, 0xffff0000, v131
    v_pk_fma_f32 v[64:65], v[200:201], v[60:61], v[64:65]
    v_pk_fma_f32 v[66:67], v[202:203], v[60:61], v[66:67]
    v_pk_fma_f32 v[68:69], v[204:205], v[60:61], v[68:69]
    v_pk_fma_f32 v[70:71], v[206:207], v[60:61], v[70:71]
    v_pk_fma_f32 v[42:43], v[42:43], v[58:59], v[64:65]
    v_pk_fma_f32 v[44:45], v[44:45], v[58:59], v[66:67]
    v_pk_fma_f32 v[46:47], v[46:47], v[58:59], v[68:69]
    v_pk_fma_f32 v[48:49], v[48:49], v[58:59], v[70:71]
    v_pk_mul_f32 v[72:73], v[42:43], v[42:43]
    v_pk_mul_f32 v[74:75], v[44:45], v[44:45]
    v_pk_mul_f32 v[76:77], v[46:47], v[46:47]
    v_pk_mul_f32 v[78:79], v[48:49], v[48:49]
    v_pk_fma_f32 v[72:73], v[72:73], v[54:55], v[52:53]
    v_pk_fma_f32 v[74:75], v[74:75], v[54:55], v[52:53]
    v_pk_fma_f32 v[76:77], v[76:77], v[54:55], v[52:53]
    v_pk_fma_f32 v[78:79], v[78:79], v[54:55], v[52:53]
    v_pk_mul_f32 v[72:73], v[42:43], v[72:73]
    v_pk_mul_f32 v[74:75], v[44:45], v[74:75]
    v_pk_mul_f32 v[76:77], v[46:47], v[76:77]
    v_pk_mul_f32 v[78:79], v[48:49], v[78:79]
    v_exp_f32 v72, v72
    v_exp_f32 v73, v73
    v_exp_f32 v74, v74
    v_exp_f32 v75, v75
    v_exp_f32 v76, v76
    v_exp_f32 v77, v77
    v_exp_f32 v78, v78
    v_exp_f32 v79, v79
    v_pk_add_f32 v[72:73], v[72:73], v[56:57]
    v_pk_add_f32 v[74:75], v[74:75], v[56:57]
    v_pk_add_f32 v[76:77], v[76:77], v[56:57]
    v_pk_add_f32 v[78:79], v[78:79], v[56:57]
    v_rcp_f32 v72, v72
    v_rcp_f32 v73, v73
    v_rcp_f32 v74, v74
    v_rcp_f32 v75, v75
    v_rcp_f32 v76, v76
    v_rcp_f32 v77, v77
    v_rcp_f32 v78, v78
    v_rcp_f32 v79, v79
    v_pk_mul_f32 v[42:43], v[42:43], v[72:73]
    v_pk_mul_f32 v[44:45], v[44:45], v[74:75]
    v_pk_mul_f32 v[46:47], v[46:47], v[76:77]
    v_pk_mul_f32 v[48:49], v[48:49], v[78:79]
    v_cvt_pk_bf16_f32 v212, v42, v43
    v_cvt_pk_bf16_f32 v213, v44, v45
    v_cvt_pk_bf16_f32 v214, v46, v47
    v_cvt_pk_bf16_f32 v215, v48, v49
    s_add_u32 s65, s65, 4096
    buffer_store_dwordx4 v[208:211], v248, s[52:55], s65 offen offset:0 sc1
    buffer_store_dwordx4 v[212:215], v248, s[52:55], s65 offen offset:1024 sc1
P4S_57:
    v_and_b32 v160, 14, v1
    v_lshlrev_b32 v160, 1, v160
    v_and_b32 v161, 1, v1
    v_add_u32 v160, v160, v161
    v_lshlrev_b32 v160, 10, v160
    s_and_b32 s70, s40, 1
    s_lshl_b32 s70, s70, 11
    s_lshl_b32 s71, s39, 7
    s_add_u32 s70, s70, s71
    s_lshl_b32 s71, s61, 2
    s_add_u32 s70, s70, s71
    v_add_u32 v160, s70, v160
    s_lshl_b32 s70, s38, 2
    s_add_u32 s70, s70, 1024
    v_mov_b32 v158, s70
    v_and_b32 v159, 3, v1
    v_lshlrev_b32 v159, 2, v159
    v_add_u32 v159, 1024, v159
    s_waitcnt vmcnt(0)
    s_mov_b32 s93, 0x7fd0a503
    v_mov_b32 v252, s93
    ds_write_b32 v158, v252
    s_cmp_lg_u32 s38, 0
    s_cbranch_scc1 SD_62
SG_61:
    ds_read_b32 v252, v159
    s_waitcnt lgkmcnt(0)
    v_cmp_ne_u32 vcc, s93, v252
    s_cbranch_vccnz SG_61
    s_cmp_lg_u32 s38, 0
    s_cbranch_scc1 PUB_63
    s_mov_b32 s92, 0x1218000
    v_mov_b32 v252, s42
    buffer_store_dword v252, v160, s[52:55], s92 offen sc1
PUB_63:
SD_62:
    s_branch P4D_55
P4I_56:
    s_barrier
    s_barrier
    s_barrier
    s_branch P4D_55
P4H_54:
    s_and_b32 s80, s40, 3
    s_lshl_b32 s80, s80, 0
    s_cmp_ge_u32 s80, 3
    s_cselect_b32 s76, 3, 0
    s_sub_u32 s80, s80, s76
    s_add_u32 s75, s80, 0
    s_cmp_ge_u32 s75, 3
    s_cselect_b32 s76, 3, 0
    s_sub_u32 s75, s75, s76
    s_add_u32 s75, s75, 0
    s_and_b32 s76, s75, 1
    s_mul_i32 s76, s76, 704512
    s_lshr_b32 s77, s75, 1
    s_lshl_b32 s77, s77, 17
    s_add_u32 s76, s76, s77
    s_add_u32 s76, s76, s72
    s_add_u32 s77, s75, 1
    s_and_b32 s77, s77, 3
    s_cmp_lt_u32 s75, 4
    s_cselect_b32 s77, s77, s75
    s_lshl_b32 s77, s77, 14
    s_add_u32 s77, s77, s73
    s_add_u32 m0, s77, 0
    s_add_u32 s65, s76, 0
    buffer_load_dwordx4 v5, s[48:51], s65 offen lds
    s_add_u32 m0, s77, 1024
    s_add_u32 s65, s76, 8192
    buffer_load_dwordx4 v5, s[48:51], s65 offen lds
    s_add_u32 m0, s77, 2048
    s_add_u32 s65, s76, 16384
    buffer_load_dwordx4 v5, s[48:51], s65 offen lds
    s_add_u32 m0, s77, 3072
    s_add_u32 s65, s76, 24576
    buffer_load_dwordx4 v5, s[48:51], s65 offen lds
    s_add_u32 s75, s80, 1
    s_cmp_ge_u32 s75, 3
    s_cselect_b32 s76, 3, 0
    s_sub_u32 s75, s75, s76
    s_add_u32 s75, s75, 0
    s_and_b32 s76, s75, 1
    s_mul_i32 s76, s76, 704512
    s_lshr_b32 s77, s75, 1
    s_lshl_b32 s77, s77, 17
    s_add_u32 s76, s76, s77
    s_add_u32 s76, s76, s72
    s_add_u32 s77, s75, 1
    s_and_b32 s77, s77, 3
    s_cmp_lt_u32 s75, 4
    s_cselect_b32 s77, s77, s75
    s_lshl_b32 s77, s77, 14
    s_add_u32 s77, s77, s73
    s_add_u32 m0, s77, 0
    s_add_u32 s65, s76, 0
    buffer_load_dwordx4 v5, s[48:51], s65 offen lds
    s_add_u32 m0, s77, 1024
    s_add_u32 s65, s76, 8192
    buffer_load_dwordx4 v5, s[48:51], s65 offen lds
    s_add_u32 m0, s77, 2048
    s_add_u32 s65, s76, 16384
    buffer_load_dwordx4 v5, s[48:51], s65 offen lds
    s_add_u32 m0, s77, 3072
    s_add_u32 s65, s76, 24576
    buffer_load_dwordx4 v5, s[48:51], s65 offen lds
    s_add_u32 s75, s80, 2
    s_cmp_ge_u32 s75, 3
    s_cselect_b32 s76, 3, 0
    s_sub_u32 s75, s75, s76
    s_add_u32 s75, s75, 0
    s_and_b32 s76, s75, 1
    s_mul_i32 s76, s76, 704512
    s_lshr_b32 s77, s75, 1
    s_lshl_b32 s77, s77, 17
    s_add_u32 s76, s76, s77
    s_add_u32 s76, s76, s72
    s_add_u32 s77, s75, 1
    s_and_b32 s77, s77, 3
    s_cmp_lt_u32 s75, 4
    s_cselect_b32 s77, s77, s75
    s_lshl_b32 s77, s77, 14
    s_add_u32 s77, s77, s73
    s_add_u32 m0, s77, 0
    s_add_u32 s65, s76, 0
    buffer_load_dwordx4 v5, s[48:51], s65 offen lds
    s_add_u32 m0, s77, 1024
    s_add_u32 s65, s76, 8192
    buffer_load_dwordx4 v5, s[48:51], s65 offen lds
    s_add_u32 m0, s77, 2048
    s_add_u32 s65, s76, 16384
    buffer_load_dwordx4 v5, s[48:51], s65 offen lds
    s_add_u32 m0, s77, 3072
    s_add_u32 s65, s76, 24576
    buffer_load_dwordx4 v5, s[48:51], s65 offen lds
    s_barrier
    ds_write_b32 v26, v24
    s_waitcnt lgkmcnt(0)
    s_barrier
    s_barrier
    s_and_b32 s80, s40, 3
    s_lshl_b32 s80, s80, 0
    s_cmp_ge_u32 s80, 3
    s_cselect_b32 s76, 3, 0
    s_sub_u32 s80, s80, s76
    s_add_u32 s75, s80, 0
    s_cmp_ge_u32 s75, 3
    s_cselect_b32 s76, 3, 0
    s_sub_u32 s75, s75, s76
    s_add_u32 s75, s75, 4
    s_and_b32 s76, s75, 1
    s_mul_i32 s76, s76, 704512
    s_lshr_b32 s77, s75, 1
    s_lshl_b32 s77, s77, 17
    s_add_u32 s76, s76, s77
    s_add_u32 s76, s76, s72
    s_add_u32 s77, s75, 1
    s_and_b32 s77, s77, 3
    s_cmp_lt_u32 s75, 4
    s_cselect_b32 s77, s77, s75
    s_lshl_b32 s77, s77, 14
    s_add_u32 s77, s77, s73
    s_add_u32 m0, s77, 0
    s_add_u32 s65, s76, 0
    buffer_load_dwordx4 v5, s[48:51], s65 offen lds
    s_add_u32 m0, s77, 1024
    s_add_u32 s65, s76, 8192
    buffer_load_dwordx4 v5, s[48:51], s65 offen lds
    s_add_u32 m0, s77, 2048
    s_add_u32 s65, s76, 16384
    buffer_load_dwordx4 v5, s[48:51], s65 offen lds
    s_add_u32 m0, s77, 3072
    s_add_u32 s65, s76, 24576
    buffer_load_dwordx4 v5, s[48:51], s65 offen lds
    s_add_u32 s75, s80, 1
    s_cmp_ge_u32 s75, 3
    s_cselect_b32 s76, 3, 0
    s_sub_u32 s75, s75, s76
    s_add_u32 s75, s75, 4
    s_and_b32 s76, s75, 1
    s_mul_i32 s76, s76, 704512
    s_lshr_b32 s77, s75, 1
    s_lshl_b32 s77, s77, 17
    s_add_u32 s76, s76, s77
    s_add_u32 s76, s76, s72
    s_add_u32 s77, s75, 1
    s_and_b32 s77, s77, 3
    s_cmp_lt_u32 s75, 4
    s_cselect_b32 s77, s77, s75
    s_lshl_b32 s77, s77, 14
    s_add_u32 s77, s77, s73
    s_add_u32 m0, s77, 0
    s_add_u32 s65, s76, 0
    buffer_load_dwordx4 v5, s[48:51], s65 offen lds
    s_add_u32 m0, s77, 1024
    s_add_u32 s65, s76, 8192
    buffer_load_dwordx4 v5, s[48:51], s65 offen lds
    s_add_u32 m0, s77, 2048
    s_add_u32 s65, s76, 16384
    buffer_load_dwordx4 v5, s[48:51], s65 offen lds
    s_add_u32 m0, s77, 3072
    s_add_u32 s65, s76, 24576
    buffer_load_dwordx4 v5, s[48:51], s65 offen lds
    s_add_u32 s75, s80, 2
    s_cmp_ge_u32 s75, 3
    s_cselect_b32 s76, 3, 0
    s_sub_u32 s75, s75, s76
    s_add_u32 s75, s75, 4
    s_and_b32 s76, s75, 1
    s_mul_i32 s76, s76, 704512
    s_lshr_b32 s77, s75, 1
    s_lshl_b32 s77, s77, 17
    s_add_u32 s76, s76, s77
    s_add_u32 s76, s76, s72
    s_add_u32 s77, s75, 1
    s_and_b32 s77, s77, 3
    s_cmp_lt_u32 s75, 4
    s_cselect_b32 s77, s77, s75
    s_lshl_b32 s77, s77, 14
    s_add_u32 s77, s77, s73
    s_add_u32 m0, s77, 0
    s_add_u32 s65, s76, 0
    buffer_load_dwordx4 v5, s[48:51], s65 offen lds
    s_add_u32 m0, s77, 1024
    s_add_u32 s65, s76, 8192
    buffer_load_dwordx4 v5, s[48:51], s65 offen lds
    s_add_u32 m0, s77, 2048
    s_add_u32 s65, s76, 16384
    buffer_load_dwordx4 v5, s[48:51], s65 offen lds
    s_add_u32 m0, s77, 3072
    s_add_u32 s65, s76, 24576
    buffer_load_dwordx4 v5, s[48:51], s65 offen lds
    s_barrier
    s_and_b32 s80, s40, 3
    s_lshl_b32 s80, s80, 0
    s_cmp_ge_u32 s80, 3
    s_cselect_b32 s76, 3, 0
    s_sub_u32 s80, s80, s76
    s_add_u32 s75, s80, 0
    s_cmp_ge_u32 s75, 3
    s_cselect_b32 s76, 3, 0
    s_sub_u32 s75, s75, s76
    s_add_u32 s75, s75, 7
    s_and_b32 s76, s75, 1
    s_mul_i32 s76, s76, 704512
    s_lshr_b32 s77, s75, 1
    s_lshl_b32 s77, s77, 17
    s_add_u32 s76, s76, s77
    s_add_u32 s76, s76, s72
    s_add_u32 s77, s75, 1
    s_and_b32 s77, s77, 3
    s_cmp_lt_u32 s75, 4
    s_cselect_b32 s77, s77, s75
    s_lshl_b32 s77, s77, 14
    s_add_u32 s77, s77, s73
    s_add_u32 m0, s77, 0
    s_add_u32 s65, s76, 0
    buffer_load_dwordx4 v5, s[48:51], s65 offen lds
    s_add_u32 m0, s77, 1024
    s_add_u32 s65, s76, 8192
    buffer_load_dwordx4 v5, s[48:51], s65 offen lds
    s_add_u32 m0, s77, 2048
    s_add_u32 s65, s76, 16384
    buffer_load_dwordx4 v5, s[48:51], s65 offen lds
    s_add_u32 m0, s77, 3072
    s_add_u32 s65, s76, 24576
    buffer_load_dwordx4 v5, s[48:51], s65 offen lds
    s_add_u32 s75, s80, 1
    s_cmp_ge_u32 s75, 3
    s_cselect_b32 s76, 3, 0
    s_sub_u32 s75, s75, s76
    s_add_u32 s75, s75, 7
    s_and_b32 s76, s75, 1
    s_mul_i32 s76, s76, 704512
    s_lshr_b32 s77, s75, 1
    s_lshl_b32 s77, s77, 17
    s_add_u32 s76, s76, s77
    s_add_u32 s76, s76, s72
    s_add_u32 s77, s75, 1
    s_and_b32 s77, s77, 3
    s_cmp_lt_u32 s75, 4
    s_cselect_b32 s77, s77, s75
    s_lshl_b32 s77, s77, 14
    s_add_u32 s77, s77, s73
    s_add_u32 m0, s77, 0
    s_add_u32 s65, s76, 0
    buffer_load_dwordx4 v5, s[48:51], s65 offen lds
    s_add_u32 m0, s77, 1024
    s_add_u32 s65, s76, 8192
    buffer_load_dwordx4 v5, s[48:51], s65 offen lds
    s_add_u32 m0, s77, 2048
    s_add_u32 s65, s76, 16384
    buffer_load_dwordx4 v5, s[48:51], s65 offen lds
    s_add_u32 m0, s77, 3072
    s_add_u32 s65, s76, 24576
    buffer_load_dwordx4 v5, s[48:51], s65 offen lds
    s_add_u32 s75, s80, 2
    s_cmp_ge_u32 s75, 3
    s_cselect_b32 s76, 3, 0
    s_sub_u32 s75, s75, s76
    s_add_u32 s75, s75, 7
    s_and_b32 s76, s75, 1
    s_mul_i32 s76, s76, 704512
    s_lshr_b32 s77, s75, 1
    s_lshl_b32 s77, s77, 17
    s_add_u32 s76, s76, s77
    s_add_u32 s76, s76, s72
    s_add_u32 s77, s75, 1
    s_and_b32 s77, s77, 3
    s_cmp_lt_u32 s75, 4
    s_cselect_b32 s77, s77, s75
    s_lshl_b32 s77, s77, 14
    s_add_u32 s77, s77, s73
    s_add_u32 m0, s77, 0
    s_add_u32 s65, s76, 0
    buffer_load_dwordx4 v5, s[48:51], s65 offen lds
    s_add_u32 m0, s77, 1024
    s_add_u32 s65, s76, 8192
    buffer_load_dwordx4 v5, s[48:51], s65 offen lds
    s_add_u32 m0, s77, 2048
    s_add_u32 s65, s76, 16384
    buffer_load_dwordx4 v5, s[48:51], s65 offen lds
    s_add_u32 m0, s77, 3072
    s_add_u32 s65, s76, 24576
    buffer_load_dwordx4 v5, s[48:51], s65 offen lds
    s_add_u32 m0, s73, 0
    s_add_u32 s65, s72, 835584
    buffer_load_dwordx4 v5, s[48:51], s65 offen lds
    s_add_u32 m0, s73, 1024
    s_add_u32 s65, s72, 843776
    buffer_load_dwordx4 v5, s[48:51], s65 offen lds
    s_add_u32 m0, s73, 2048
    s_add_u32 s65, s72, 851968
    buffer_load_dwordx4 v5, s[48:51], s65 offen lds
    s_add_u32 m0, s73, 3072
    s_add_u32 s65, s72, 860160
    buffer_load_dwordx4 v5, s[48:51], s65 offen lds
    s_branch P4Z_64
P4D_55:
    s_waitcnt lgkmcnt(0)
    s_barrier
P4Z_64:
    s_and_b32 s60, s40, 3
    s_lshl_b32 s62, s39, 2
    s_add_u32 s60, s60, s62
    s_lshr_b32 s61, s40, 2
    s_cmp_ge_u32 s38, 4
    s_cbranch_scc1 P5H_65
    s_and_b32 s62, s38, 1
    s_lshr_b32 s63, s38, 1
    s_lshl_b32 s64, s60, 1
    s_add_u32 s64, s64, s62
    s_mov_b32 s56, s30
    s_mov_b32 s57, s31
    s_mov_b32 s58, 0x400
    s_mov_b32 s59, 0x20000
    s_mov_b32 s48, s32
    s_mov_b32 s49, s33
    s_mov_b32 s50, 0x200000
    s_mov_b32 s51, 0x20000
    s_mul_i32 s65, s64, 88064
    s_mul_i32 s71, s63, 44032
    s_add_u32 s65, s65, s71
    s_add_u32 s65, s65, 0xa00000
    s_add_u32 s44, s36, s65
    s_addc_u32 s45, s37, 0
    s_mov_b32 s46, 0xac00
    s_mov_b32 s47, 0x20000
    v_and_b32 v100, 31, v1
    v_lshrrev_b32 v101, 5, v1
    v_lshlrev_b32 v102, 4, v1
    v_lshlrev_b32 v103, 3, v101
    s_lshl_b32 s65, s61, 7
    s_lshl_b32 s71, s63, 6
    s_add_u32 s65, s65, s71
    buffer_load_dwordx2 v[90:91], v103, s[56:59], s65 offen offset:0
    buffer_load_dwordx2 v[92:93], v103, s[56:59], s65 offen offset:16
    buffer_load_dwordx2 v[94:95], v103, s[56:59], s65 offen offset:32
    buffer_load_dwordx2 v[96:97], v103, s[56:59], s65 offen offset:48
    v_and_b32 v104, 15, v1
    v_lshrrev_b32 v105, 5, v1
    v_lshrrev_b32 v106, 2, v104
    v_lshl_add_u32 v106, v105, 2, v106
    v_lshlrev_b32 v106, 7, v106
    v_lshrrev_b32 v107, 3, v104
    v_lshl_add_u32 v106, v107, 6, v106
    v_bfe_u32 v107, v1, 4, 1
    v_lshl_add_u32 v106, v107, 5, v106
    v_and_b32 v107, 3, v104
    v_lshl_add_u32 v88, v107, 3, v106
    v_xor_b32 v89, 64, v88
    s_sub_u32 s65, s61, 5
    s_cmp_ge_u32 s61, 5
    s_cselect_b32 s66, s65, s61
    s_mov_b32 s67, 0
    s_lshl_b32 s71, s66, 1
    s_add_u32 s71, s71, s63
    s_add_u32 s74, s71, 1
    s_and_b32 s74, s74, 3
    s_cmp_lt_u32 s71, 4
    s_cselect_b32 s71, s74, s71
    s_lshl_b32 s70, s71, 14
    v_add_u32 v84, s70, v88
    v_add_u32 v85, s70, v89
    v_mov_b32 v2, 0
    v_mov_b32 v3, 0
    v_mov_b32 v4, 0
    v_mov_b32 v5, 0
    v_mov_b32 v6, 0
    v_mov_b32 v7, 0
    v_mov_b32 v8, 0
    v_mov_b32 v9, 0
    v_mov_b32 v10, 0
    v_mov_b32 v11, 0
    v_mov_b32 v12, 0
    v_mov_b32 v13, 0
    v_mov_b32 v14, 0
    v_mov_b32 v15, 0
    v_mov_b32 v16, 0
    v_mov_b32 v17, 0
    v_mov_b32 v18, 0
    v_mov_b32 v19, 0
    v_mov_b32 v20, 0
    v_mov_b32 v21, 0
    v_mov_b32 v22, 0
    v_mov_b32 v23, 0
    v_mov_b32 v24, 0
    v_mov_b32 v25, 0
    v_mov_b32 v26, 0
    v_mov_b32 v27, 0
    v_mov_b32 v28, 0
    v_mov_b32 v29, 0
    v_mov_b32 v30, 0
    v_mov_b32 v31, 0
    v_mov_b32 v32, 0
    v_mov_b32 v33, 0
    v_and_b32 v104, 15, v1
    v_min_u32 v104, 14, v104
    v_lshlrev_b32 v104, 2, v104
    s_lshl_b32 s65, s2, 7
    v_add_u32 v104, s65, v104
    s_cmp_lg_u32 s38, 0
    s_cbranch_scc1 POD_68
    s_mov_b32 s92, 0x1218000
    s_mov_b32 s43, 300000
POL_67:
    buffer_load_dword v105, v104, s[52:55], s92 offen sc1
    s_waitcnt vmcnt(0)
    v_cmp_ne_u32 vcc, s42, v105
    s_cbranch_vccz POD_68
    s_sub_u32 s43, s43, 1
    s_cbranch_scc0 POL_67
POD_68:
    s_barrier
    s_lshl_b32 s68, s66, 13
    s_add_u32 s69, s68, 4096
    buffer_load_dwordx4 v[36:39], v102, s[44:47], s68 offen offset:0 sc1
    buffer_load_dwordx4 v[40:43], v102, s[44:47], s68 offen offset:1024 sc1
    buffer_load_dwordx4 v[44:47], v102, s[44:47], s68 offen offset:2048 sc1
    buffer_load_dwordx4 v[48:51], v102, s[44:47], s68 offen offset:3072 sc1
    buffer_load_dwordx4 v[52:55], v102, s[44:47], s69 offen offset:0 sc1
    buffer_load_dwordx4 v[56:59], v102, s[44:47], s69 offen offset:1024 sc1
    buffer_load_dwordx4 v[60:63], v102, s[44:47], s69 offen offset:2048 sc1
    buffer_load_dwordx4 v[64:67], v102, s[44:47], s69 offen offset:3072 sc1
    ds_read_b64_tr_b16 v[68:69], v84 offset:0
    ds_read_b64_tr_b16 v[70:71], v84 offset:1024
    ds_read_b64_tr_b16 v[72:73], v85 offset:0
    ds_read_b64_tr_b16 v[74:75], v85 offset:1024
    ds_read_b64_tr_b16 v[76:77], v84 offset:2048
    ds_read_b64_tr_b16 v[78:79], v84 offset:3072
    ds_read_b64_tr_b16 v[80:81], v85 offset:2048
    ds_read_b64_tr_b16 v[82:83], v85 offset:3072
P5L_69:
    s_add_u32 s66, s66, 1
    s_cmp_eq_u32 s66, 5
    s_cselect_b32 s66, 0, s66
    s_lshl_b32 s71, s66, 1
    s_add_u32 s71, s71, s63
    s_add_u32 s74, s71, 1
    s_and_b32 s74, s74, 3
    s_cmp_lt_u32 s71, 4
    s_cselect_b32 s71, s74, s71
    s_lshl_b32 s75, s71, 14
    s_lshl_b32 s68, s66, 13
    s_cmp_eq_u32 s67, 4
    s_cselect_b32 s68, 40960, s68
    s_cselect_b32 s75, s70, s75
    s_add_u32 s69, s68, 4096
    v_add_u32 v86, s75, v88
    v_add_u32 v87, s75, v89
    s_barrier
    s_waitcnt vmcnt(7) lgkmcnt(4)
    v_mfma_f32_32x32x16_bf16 v[2:17], v[68:71], v[36:39], v[2:17]
    ds_read_b64_tr_b16 v[128:129], v84 offset:4096
    ds_read_b64_tr_b16 v[130:131], v84 offset:5120
    v_mfma_f32_32x32x16_bf16 v[18:33], v[72:75], v[36:39], v[18:33]
    ds_read_b64_tr_b16 v[132:133], v85 offset:4096
    ds_read_b64_tr_b16 v[134:135], v85 offset:5120
    buffer_load_dwordx4 v[36:39], v102, s[44:47], s68 offen offset:0 sc1
    s_waitcnt vmcnt(7) lgkmcnt(4)
    v_mfma_f32_32x32x16_bf16 v[2:17], v[76:79], v[40:43], v[2:17]
    ds_read_b64_tr_b16 v[136:137], v84 offset:6144
    ds_read_b64_tr_b16 v[138:139], v84 offset:7168
    v_mfma_f32_32x32x16_bf16 v[18:33], v[80:83], v[40:43], v[18:33]
    ds_read_b64_tr_b16 v[140:141], v85 offset:6144
    ds_read_b64_tr_b16 v[142:143], v85 offset:7168
    buffer_load_dwordx4 v[40:43], v102, s[44:47], s68 offen offset:1024 sc1
    s_waitcnt vmcnt(7) lgkmcnt(4)
    v_mfma_f32_32x32x16_bf16 v[2:17], v[128:131], v[44:47], v[2:17]
    ds_read_b64_tr_b16 v[68:69], v84 offset:8192
    ds_read_b64_tr_b16 v[70:71], v84 offset:9216
    v_mfma_f32_32x32x16_bf16 v[18:33], v[132:135], v[44:47], v[18:33]
    ds_read_b64_tr_b16 v[72:73], v85 offset:8192
    ds_read_b64_tr_b16 v[74:75], v85 offset:9216
    buffer_load_dwordx4 v[44:47], v102, s[44:47], s68 offen offset:2048 sc1
    s_waitcnt vmcnt(7) lgkmcnt(4)
    v_mfma_f32_32x32x16_bf16 v[2:17], v[136:139], v[48:51], v[2:17]
    ds_read_b64_tr_b16 v[76:77], v84 offset:10240
    ds_read_b64_tr_b16 v[78:79], v84 offset:11264
    v_mfma_f32_32x32x16_bf16 v[18:33], v[140:143], v[48:51], v[18:33]
    ds_read_b64_tr_b16 v[80:81], v85 offset:10240
    ds_read_b64_tr_b16 v[82:83], v85 offset:11264
    buffer_load_dwordx4 v[48:51], v102, s[44:47], s68 offen offset:3072 sc1
    s_waitcnt vmcnt(7) lgkmcnt(4)
    v_mfma_f32_32x32x16_bf16 v[2:17], v[68:71], v[52:55], v[2:17]
    ds_read_b64_tr_b16 v[128:129], v84 offset:12288
    ds_read_b64_tr_b16 v[130:131], v84 offset:13312
    v_mfma_f32_32x32x16_bf16 v[18:33], v[72:75], v[52:55], v[18:33]
    ds_read_b64_tr_b16 v[132:133], v85 offset:12288
    ds_read_b64_tr_b16 v[134:135], v85 offset:13312
    buffer_load_dwordx4 v[52:55], v102, s[44:47], s69 offen offset:0 sc1
    s_waitcnt vmcnt(7) lgkmcnt(4)
    v_mfma_f32_32x32x16_bf16 v[2:17], v[76:79], v[56:59], v[2:17]
    ds_read_b64_tr_b16 v[136:137], v84 offset:14336
    ds_read_b64_tr_b16 v[138:139], v84 offset:15360
    v_mfma_f32_32x32x16_bf16 v[18:33], v[80:83], v[56:59], v[18:33]
    ds_read_b64_tr_b16 v[140:141], v85 offset:14336
    ds_read_b64_tr_b16 v[142:143], v85 offset:15360
    buffer_load_dwordx4 v[56:59], v102, s[44:47], s69 offen offset:1024 sc1
    s_waitcnt vmcnt(7) lgkmcnt(4)
    v_mfma_f32_32x32x16_bf16 v[2:17], v[128:131], v[60:63], v[2:17]
    ds_read_b64_tr_b16 v[68:69], v86 offset:0
    ds_read_b64_tr_b16 v[70:71], v86 offset:1024
    v_mfma_f32_32x32x16_bf16 v[18:33], v[132:135], v[60:63], v[18:33]
    ds_read_b64_tr_b16 v[72:73], v87 offset:0
    ds_read_b64_tr_b16 v[74:75], v87 offset:1024
    buffer_load_dwordx4 v[60:63], v102, s[44:47], s69 offen offset:2048 sc1
    s_waitcnt vmcnt(7) lgkmcnt(4)
    v_mfma_f32_32x32x16_bf16 v[2:17], v[136:139], v[64:67], v[2:17]
    ds_read_b64_tr_b16 v[76:77], v86 offset:2048
    ds_read_b64_tr_b16 v[78:79], v86 offset:3072
    v_mfma_f32_32x32x16_bf16 v[18:33], v[140:143], v[64:67], v[18:33]
    ds_read_b64_tr_b16 v[80:81], v87 offset:2048
    ds_read_b64_tr_b16 v[82:83], v87 offset:3072
    buffer_load_dwordx4 v[64:67], v102, s[44:47], s69 offen offset:3072 sc1
    v_mov_b32 v84, v86
    v_mov_b32 v85, v87
    s_add_u32 s67, s67, 1
    s_cmp_lt_u32 s67, 5
    s_cbranch_scc1 P5L_69
    s_waitcnt vmcnt(7) lgkmcnt(4)
    v_mfma_f32_32x32x16_bf16 v[2:17], v[68:71], v[36:39], v[2:17]
    ds_read_b64_tr_b16 v[128:129], v84 offset:4096
    ds_read_b64_tr_b16 v[130:131], v84 offset:5120
    v_mfma_f32_32x32x16_bf16 v[18:33], v[72:75], v[36:39], v[18:33]
    ds_read_b64_tr_b16 v[132:133], v85 offset:4096
    ds_read_b64_tr_b16 v[134:135], v85 offset:5120
    s_waitcnt vmcnt(6) lgkmcnt(4)
    v_mfma_f32_32x32x16_bf16 v[2:17], v[76:79], v[40:43], v[2:17]
    v_mfma_f32_32x32x16_bf16 v[18:33], v[80:83], v[40:43], v[18:33]
    s_waitcnt vmcnt(5) lgkmcnt(0)
    v_mfma_f32_32x32x16_bf16 v[2:17], v[128:131], v[44:47], v[2:17]
    v_mfma_f32_32x32x16_bf16 v[18:33], v[132:135], v[44:47], v[18:33]
    s_barrier
    s_nop 11
    s_cmp_eq_u32 s63, 0
    s_cbranch_scc1 P5k_70
    v_mov_b32 v112, v2
    v_mov_b32 v2, v18
    v_mov_b32 v18, v112
    v_mov_b32 v113, v3
    v_mov_b32 v3, v19
    v_mov_b32 v19, v113
    v_mov_b32 v114, v4
    v_mov_b32 v4, v20
    v_mov_b32 v20, v114
    v_mov_b32 v115, v5
    v_mov_b32 v5, v21
    v_mov_b32 v21, v115
    v_mov_b32 v116, v6
    v_mov_b32 v6, v22
    v_mov_b32 v22, v116
    v_mov_b32 v117, v7
    v_mov_b32 v7, v23
    v_mov_b32 v23, v117
    v_mov_b32 v118, v8
    v_mov_b32 v8, v24
    v_mov_b32 v24, v118
    v_mov_b32 v119, v9
    v_mov_b32 v9, v25
    v_mov_b32 v25, v119
    v_mov_b32 v120, v10
    v_mov_b32 v10, v26
    v_mov_b32 v26, v120
    v_mov_b32 v121, v11
    v_mov_b32 v11, v27
    v_mov_b32 v27, v121
    v_mov_b32 v122, v12
    v_mov_b32 v12, v28
    v_mov_b32 v28, v122
    v_mov_b32 v123, v13
    v_mov_b32 v13, v29
    v_mov_b32 v29, v123
    v_mov_b32 v124, v14
    v_mov_b32 v14, v30
    v_mov_b32 v30, v124
    v_mov_b32 v125, v15
    v_mov_b32 v15, v31
    v_mov_b32 v31, v125
    v_mov_b32 v126, v16
    v_mov_b32 v16, v32
    v_mov_b32 v32, v126
    v_mov_b32 v127, v17
    v_mov_b32 v17, v33
    v_mov_b32 v33, v127
P5k_70:
    s_lshl_b32 s70, s38, 12
    s_add_u32 s70, s70, 0
    v_lshlrev_b32 v104, 4, v1
    v_add_u32 v105, s70, v104
    s_xor_b32 s71, s38, 2
    s_lshl_b32 s71, s71, 12
    s_add_u32 s71, s71, 0
    v_add_u32 v106, s71, v104
    ds_write_b128 v105, v[18:21] offset:0
    ds_write_b128 v105, v[22:25] offset:1024
    ds_write_b128 v105, v[26:29] offset:2048
    ds_write_b128 v105, v[30:33] offset:3072
    s_waitcnt lgkmcnt(0)
    s_barrier
    ds_read_b128 v[112:115], v106 offset:0
    ds_read_b128 v[116:119], v106 offset:1024
    ds_read_b128 v[120:123], v106 offset:2048
    ds_read_b128 v[124:127], v106 offset:3072
    s_waitcnt lgkmcnt(0)
    v_add_f32 v2, v2, v112
    v_add_f32 v3, v3, v113
    v_add_f32 v4, v4, v114
    v_add_f32 v5, v5, v115
    v_add_f32 v6, v6, v116
    v_add_f32 v7, v7, v117
    v_add_f32 v8, v8, v118
    v_add_f32 v9, v9, v119
    v_add_f32 v10, v10, v120
    v_add_f32 v11, v11, v121
    v_add_f32 v12, v12, v122
    v_add_f32 v13, v13, v123
    v_add_f32 v14, v14, v124
    v_add_f32 v15, v15, v125
    v_add_f32 v16, v16, v126
    v_add_f32 v17, v17, v127
    v_lshlrev_b32 v104, 16, v240
    v_and_b32 v105, 0xffff0000, v240
    v_lshlrev_b32 v106, 16, v90
    v_and_b32 v107, 0xffff0000, v90
    v_add_f32 v2, v2, v106
    v_add_f32 v3, v3, v107
    v_add_f32 v2, v2, v104
    v_add_f32 v3, v3, v105
    v_lshlrev_b32 v104, 16, v241
    v_and_b32 v105, 0xffff0000, v241
    v_lshlrev_b32 v106, 16, v91
    v_and_b32 v107, 0xffff0000, v91
    v_add_f32 v4, v4, v106
    v_add_f32 v5, v5, v107
    v_add_f32 v4, v4, v104
    v_add_f32 v5, v5, v105
    v_lshlrev_b32 v104, 16, v242
    v_and_b32 v105, 0xffff0000, v242
    v_lshlrev_b32 v106, 16, v92
    v_and_b32 v107, 0xffff0000, v92
    v_add_f32 v6, v6, v106
    v_add_f32 v7, v7, v107
    v_add_f32 v6, v6, v104
    v_add_f32 v7, v7, v105
    v_lshlrev_b32 v104, 16, v243
    v_and_b32 v105, 0xffff0000, v243
    v_lshlrev_b32 v106, 16, v93
    v_and_b32 v107, 0xffff0000, v93
    v_add_f32 v8, v8, v106
    v_add_f32 v9, v9, v107
    v_add_f32 v8, v8, v104
    v_add_f32 v9, v9, v105
    v_lshlrev_b32 v104, 16, v244
    v_and_b32 v105, 0xffff0000, v244
    v_lshlrev_b32 v106, 16, v94
    v_and_b32 v107, 0xffff0000, v94
    v_add_f32 v10, v10, v106
    v_add_f32 v11, v11, v107
    v_add_f32 v10, v10, v104
    v_add_f32 v11, v11, v105
    v_lshlrev_b32 v104, 16, v245
    v_and_b32 v105, 0xffff0000, v245
    v_lshlrev_b32 v106, 16, v95
    v_and_b32 v107, 0xffff0000, v95
    v_add_f32 v12, v12, v106
    v_add_f32 v13, v13, v107
    v_add_f32 v12, v12, v104
    v_add_f32 v13, v13, v105
    v_lshlrev_b32 v104, 16, v246
    v_and_b32 v105, 0xffff0000, v246
    v_lshlrev_b32 v106, 16, v96
    v_and_b32 v107, 0xffff0000, v96
    v_add_f32 v14, v14, v106
    v_add_f32 v15, v15, v107
    v_add_f32 v14, v14, v104
    v_add_f32 v15, v15, v105
    v_lshlrev_b32 v104, 16, v247
    v_and_b32 v105, 0xffff0000, v247
    v_lshlrev_b32 v106, 16, v97
    v_and_b32 v107, 0xffff0000, v97
    v_add_f32 v16, v16, v106
    v_add_f32 v17, v17, v107
    v_add_f32 v16, v16, v104
    v_add_f32 v17, v17, v105
    v_cvt_pk_bf16_f32 v128, v2, v3
    v_cvt_pk_bf16_f32 v129, v4, v5
    v_cvt_pk_bf16_f32 v130, v6, v7
    v_cvt_pk_bf16_f32 v131, v8, v9
    v_cvt_pk_bf16_f32 v132, v10, v11
    v_cvt_pk_bf16_f32 v133, v12, v13
    v_cvt_pk_bf16_f32 v134, v14, v15
    v_cvt_pk_bf16_f32 v135, v16, v17
    s_nop 1
    v_permlane32_swap_b32 v128, v130
    v_permlane32_swap_b32 v129, v131
    v_permlane32_swap_b32 v132, v134
    v_permlane32_swap_b32 v133, v135
    v_lshlrev_b32 v104, 10, v100
    v_lshl_add_u32 v104, v101, 4, v104
    s_lshl_b32 s65, s64, 15
    s_lshl_b32 s71, s61, 7
    s_add_u32 s65, s65, s71
    s_lshl_b32 s71, s63, 6
    s_add_u32 s65, s65, s71
    buffer_store_dwordx4 v[128:131], v104, s[48:51], s65 offen
    buffer_store_dwordx4 v[132:135], v104, s[48:51], s65 offen offset:32
    s_branch P5D_66
P5H_65:
    s_lshr_b32 s62, s41, 1
    s_and_b32 s63, s41, 1
    s_sub_u32 s65, s61, 5
    s_cmp_ge_u32 s61, 5
    s_cselect_b32 s66, s65, s61
    s_lshl_b32 s71, s66, 1
    s_add_u32 s71, s71, s62
    s_add_u32 s74, s71, 1
    s_and_b32 s74, s74, 3
    s_cmp_lt_u32 s71, 4
    s_cselect_b32 s71, s74, s71
    s_lshl_b32 s66, s71, 14
    s_mul_i32 s65, s63, 3072
    s_add_u32 s66, s66, s65
    s_mul_i32 s64, s62, 704512
    s_mul_i32 s65, s63, 24576
    s_add_u32 s64, s64, s65
    s_lshl_b32 s65, s61, 7
    s_add_u32 s64, s64, s65
    s_waitcnt vmcnt(0)
    s_barrier
    s_barrier
    s_barrier
    s_add_u32 m0, s66, 0
    s_add_u32 s65, s64, 655360
    buffer_load_dwordx4 v5, s[48:51], s65 offen lds
    s_add_u32 m0, s66, 1024
    s_add_u32 s65, s64, 663552
    buffer_load_dwordx4 v5, s[48:51], s65 offen lds
    s_add_u32 m0, s66, 2048
    s_add_u32 s65, s64, 671744
    buffer_load_dwordx4 v5, s[48:51], s65 offen lds
    s_barrier
    s_barrier
    s_waitcnt vmcnt(0)
    s_barrier
    s_barrier
    s_barrier
P5D_66:
L_end_sequential_preLN__sliding_block__dense_activation_gelu__prompt_kernel:
    s_endpgm
.section .rodata,"a"
.p2align 6
.amdhsa_kernel sequential_preLN__sliding_block__dense_activation_gelu__prompt_kernel
  .amdhsa_next_free_vgpr 256
  .amdhsa_next_free_sgpr 102
  .amdhsa_accum_offset 256
  .amdhsa_group_segment_fixed_size 0
  .amdhsa_kernarg_size 88
  .amdhsa_user_sgpr_count 2
  .amdhsa_user_sgpr_kernarg_segment_ptr 1
  .amdhsa_system_sgpr_workgroup_id_x 1
.end_amdhsa_kernel
```
